```python
import torch

def _softmax(x, axis=-1):
    return torch.softmax(x, dim=axis)
def _gelu(x):
    return torch.nn.functional.gelu(x, approximate="tanh")
def _silu(x):
    return torch.nn.functional.silu(x)
def _sigmoid(x):
    return torch.sigmoid(x)
def _layernorm(x, axis=-1, eps=1e-5):
    m = x.mean(dim=axis, keepdim=True)
    v = x.var(dim=axis, keepdim=True, unbiased=False)
    return (x - m) / torch.sqrt(v + eps)
def _scatter_add(tgt, idx, src, axis=0):
    return tgt.clone().index_add_(axis, idx, src)
def _segment_sum(src, seg, n):
    out = torch.zeros((n,) + src.shape[1:], dtype=src.dtype)
    return out.index_add_(0, seg, src)
def _pad(x, pw):
    flat = tuple(v for pair in reversed(pw) for v in pair)
    return torch.nn.functional.pad(x, flat)

kernel_name = 'gated_mix__ssm_conv_h3__dense_activation_gelu__prompt'

def setup_inputs():

    _w = (lambda a: (lambda t: t.to(torch.bfloat16) if t.is_floating_point() else t)(torch.as_tensor(a)))
    def _A_setup():
        B, S, D = 1, 2048, 512
        ks = 4
        return {
            "q": _w((lambda *s: torch.randn(*s, dtype=torch.bfloat16) * 0.05)(B, S, D)),
            "k": _w((lambda *s: torch.randn(*s, dtype=torch.bfloat16) * 0.2)(B, S, D)),
            "v": _w((lambda *s: torch.randn(*s, dtype=torch.bfloat16) * 0.2)(B, S, D)),
            "shift_k": _w((lambda *s: torch.randn(*s, dtype=torch.bfloat16) * 0.2)(D, ks) * 0.5),
            "ssm_k": _w((lambda *s: torch.randn(*s, dtype=torch.bfloat16) * 0.8)(D, S) * (1.0 / S ** 0.5)),
            "ssm_D": _w((lambda *s: torch.randn(*s, dtype=torch.bfloat16) * 0.2)(D)),
        }
    _A_in = _A_setup()

    def _B_setup():
        B, S, D, F = 1, 2048, 512, 1376
        return {
            "x": _w((lambda *s: torch.randn(*s, dtype=torch.bfloat16) * 0.05)(B, S, D)),
            "w1": _w((lambda *s: torch.randn(*s, dtype=torch.bfloat16) * 3.2)(D, F) * (D ** -0.5)),
            "b1": _w((lambda *s: torch.randn(*s, dtype=torch.bfloat16) * 3.2)(F) * 0.01),
            "w2": _w((lambda *s: torch.randn(*s, dtype=torch.bfloat16) * 0.05)(F, D) * (F ** -0.5)),
            "b2": _w((lambda *s: torch.randn(*s, dtype=torch.bfloat16) * 0.1)(D) * 0.01),
        }
    _B_in = _B_setup()

    return {
        "A_q": _A_in["q"],
        "A_k": _A_in["k"],
        "A_v": _A_in["v"],
        "A_shift_k": _A_in["shift_k"],
        "A_ssm_k": _A_in["ssm_k"],
        "A_ssm_D": _A_in["ssm_D"],
        "B_x": _B_in["x"],
        "B_w1": _B_in["w1"],
        "B_b1": _B_in["b1"],
        "B_w2": _B_in["w2"],
        "B_b2": _B_in["b2"],
        "gate_w": _w((lambda *s: torch.randn(*s, dtype=torch.bfloat16) * 0.05)(512) * 16.0),
    }

def reference(A_q, A_k, A_v, A_shift_k, A_ssm_k, A_ssm_D, B_x, B_w1, B_b1, B_w2, B_b2, gate_w):
    def _A_ref(q, k, v, shift_k, ssm_k, ssm_D):
        B, S, D = q.shape
        ks = shift_k.shape[-1]
        k_pad = _pad(k, ((0, 0), (ks - 1, 0), (0, 0)))
        k_shift = torch.zeros_like(k)
        for t in range(ks):
            k_shift = k_shift + k_pad[:, t:t + S, :] * shift_k[:, ks - 1 - t][None, None, :]
        kv = k_shift * v
        L = 2 * S
        kv_pad = _pad(kv, ((0, 0), (0, S), (0, 0)))
        kf_pad = _pad(ssm_k, ((0, 0), (0, S)))
        kv_f = (lambda x, axes=(-2,-1): torch.fft.rfft2(x.float(), dim=axes))(kv_pad[:, None, :, :], axes=(1, 2))
        kf_f = (lambda x, axes=(-2,-1): torch.fft.rfft2(x.float(), dim=axes))(kf_pad[:, None, :], axes=(1, 2))
        kf_f = (lambda x, *d: x.permute(*d))(kf_f, 1, 2, 0)
        y_f = kv_f * kf_f[None, :, :, :]
        y = (lambda x, s, axes=(-2,-1): torch.fft.irfft2(x, s=s, dim=axes).to(torch.bfloat16))(y_f, (1, L), axes=(1, 2))[:, 0, :S, :]
        y = y + kv * ssm_D[None, None, :]
        return q * y

    def _B_ref(x, w1, b1, w2, b2):
        h = torch.einsum("bsd,df->bsf", x, w1) + b1
        h = _gelu(h)
        return torch.einsum("bsf,fd->bsd", h, w2) + b2

    x = A_q
    g = _sigmoid((x * gate_w).sum(-1, keepdims=True))
    a = _A_ref(x, A_k, A_v, A_shift_k, A_ssm_k, A_ssm_D)
    b = _B_ref(x, B_w1, B_b1, B_w2, B_b2)
    return g * a + (1 - g) * b
```

```asm
; @launch grid=(256,1,1) block=(512,1,1) lds=163840
.amdgcn_target "amdgcn-amd-amdhsa--gfx950"
.text
.globl gated_mix__ssm_conv_h3__dense_activation_gelu__prompt_kernel
.p2align 8
.type gated_mix__ssm_conv_h3__dense_activation_gelu__prompt_kernel,@function
gated_mix__ssm_conv_h3__dense_activation_gelu__prompt_kernel:
L_codestart:
    s_cmp_ge_u32 s2, 256
    s_cbranch_scc1 L_end
    v_lshrrev_b32 v125, 6, v0
    s_load_dwordx16 s[64:79], s[0:1], 0
    v_readfirstlane_b32 s40, v125
    s_load_dwordx8 s[80:87], s[0:1], 64
    s_load_dwordx2 s[92:93], s[0:1], 96
    s_load_dwordx2 s[28:29], s[0:1], 112
    s_getpc_b64 s[60:61]
    s_and_b32 s56, s2, 0xf8
    v_and_b32 v126, 7, v0
    v_or_b32 v126, s56, v126
    v_lshlrev_b32 v126, 7, v126
    v_min_u32 v126, L_codeend-L_codestart-128, v126
    s_cmp_lg_u32 s40, 7
    s_cbranch_scc1 L_npf
    global_load_dword v131, v126, s[60:61]
L_npf:
    s_mov_b32 s34, 0x50401808
    s_mov_b32 s35, 0x58585870
    s_lshl_b32 s56, s40, 3
    s_lshr_b64 s[34:35], s[34:35], s56
    s_and_b32 s58, s34, 0xff
    s_load_dwordx2 s[36:37], s[0:1], s58
    v_and_b32 v120, 63, v0
    v_lshrrev_b32 v122, 3, v120
    v_and_b32 v123, 7, v120
    v_lshlrev_b32 v130, 10, v122
    v_lshl_add_u32 v130, v123, 4, v130
    s_and_b32 s56, s2, 7
    s_lshr_b32 s51, s2, 6
    s_bfe_u32 s44, s2, 0x30003
    s_mov_b32 s97, s44
    s_lshl_b32 s43, s56, 2
    s_add_u32 s43, s43, s51
    s_lshl_b32 s63, s43, 16
    s_lshl_b32 s57, s44, 7
    s_add_u32 s63, s63, s57
    s_and_b32 s59, s40, 3
    s_lshl_b32 s12, s59, 13
    s_add_u32 s12, s12, s63
    s_add_u32 s13, s12, 32768
    s_mul_i32 s14, s59, 1040
    s_cmp_ge_u32 s40, 4
    s_cselect_b32 s15, 8320, 0
    s_add_u32 s14, s14, s15
    s_add_u32 s14, s14, 98048
    s_mov_b32 s10, 2097152
    s_mov_b32 s11, 0x20000
    s_mov_b32 s18, 2097152
    s_mov_b32 s19, 0x20000
    v_lshlrev_b32_e64 v1, 4, v120
    s_mov_b32 m0, s14
    s_cmp_ge_u32 s40, 4
    s_waitcnt lgkmcnt(0)
    s_cselect_b64 s[8:9], s[68:69], s[66:67]
    s_and_b32 s9, s9, 0xffff
    buffer_load_dwordx4 v130, s[8:11], s12 offen nt lds
    s_add_u32 m0, s14, 4160
    s_mov_b32 s16, s72
    buffer_load_dwordx4 v130, s[8:11], s13 offen nt lds
    s_and_b32 s17, s73, 0xffff
    s_and_b32 s41, s56, 6
    s_lshl_b32 s41, s41, 1
    s_add_u32 s41, s41, s51
    s_lshr_b32 s48, s56, 1
    s_lshl_b32 s59, s97, 1
    s_add_u32 s48, s48, s59
    s_lshl_b32 s59, s51, 2
    s_add_u32 s48, s48, s59
    s_and_b32 s59, s56, 1
    s_add_u32 s48, s48, s59
    s_and_b32 s48, s48, 7
    s_lshl_b32 s48, s48, 7
    s_and_b32 s96, s56, 1
    s_lshl_b32 s56, s96, 3
    s_add_u32 s42, s56, s97
    s_and_b32 s59, s42, 3
    s_lshr_b32 s56, s42, 2
    s_mul_i32 s45, s56, 11
    s_mul_i32 s56, s59, 3
    s_add_u32 s45, s45, s56
    s_cmp_eq_u32 s59, 3
    s_cselect_b32 s46, 8, 12
    s_cmp_eq_u32 s42, 15
    s_cselect_b32 s46, 4, s46
    s_mov_b32 s38, 1024
    s_mov_b32 s32, s48
    s_mov_b32 s33, 161280
    s_cmp_eq_u32 s40, 5
    s_cselect_b32 s56, s42, 0
    s_cselect_b32 s58, 1023, -1
    s_cmp_eq_u32 s56, 15
    s_cselect_b64 s[34:35], -1, 0
    s_lshl_b32 s56, s44, 9
    s_lshl_b32 s59, s45, 6
    s_cmp_eq_u32 s40, 1
    s_cselect_b32 s38, 4096, s38
    s_cselect_b32 s32, s56, s32
    s_cselect_b32 s33, 157696, s33
    s_cselect_b32 s34, -1, s34
    s_cmp_eq_u32 s40, 2
    s_cselect_b32 s38, 2752, s38
    s_cselect_b32 s32, s59, s32
    s_cselect_b32 s33, 158208, s33
    s_cselect_b32 s34, 4095, s34
    s_cmp_eq_u32 s40, 3
    s_cselect_b32 s32, s57, s32
    s_cselect_b32 s33, 158464, s33
    s_cselect_b32 s34, 255, s34
    s_cmp_eq_u32 s40, 4
    s_cselect_b32 s38, 16777216, s38
    s_cselect_b32 s32, 14417920, s32
    s_cselect_b32 s33, 158720, s33
    s_cselect_b32 s34, 1, s34
    v_add_u32 v129, s32, v1
    v_and_b32_e64 v129, s58, v129
    s_cmp_lg_u32 s40, 0
    s_cbranch_scc1 L_nh
    s_mov_b32 s38, 2097152
    s_mov_b32 s33, 97008
    s_mov_b32 s35, 0xffffff00
    s_sub_u32 s56, s63, 8192
    v_add_u32_e64 v129, s56, v130
L_nh:
    s_mov_b32 s39, 0x20000
    s_and_b32 s37, s37, 0xffff
    s_mov_b32 m0, s33
    s_mov_b64 exec, s[34:35]
    s_cbranch_execz L_spn
    buffer_load_dwordx4 v129, s[36:39], 0 offen sc1 lds
L_spn:
    s_mov_b64 exec, -1
    s_barrier
    v_lshrrev_b32 v124, 4, v120
    v_mov_b32 v128, 2147483648
    v_mov_b32_e64 v3, 0
    s_mov_b32 s30, 16777216
    s_mov_b32 s31, 0x20000
    s_and_b32 s29, s29, 0xffff
    s_and_b32 s56, s40, 4
    s_and_b32 s40, s40, 3
    s_lshl_b32 s50, s40, 14
    s_and_b32 s52, s40, 1
    s_lshr_b32 s53, s40, 1
    s_mov_b32 s96, 0xffff0000
    s_cmp_lg_u32 s56, 0
    s_cbranch_scc1 L_G
    v_xor_b32 v6, v123, v124
    v_lshlrev_b32 v6, 4, v6
    v_lshl_add_u32 v6, v122, 10, v6
    v_xor_b32 v7, 64, v6
    v_add_u32 v7, 7168, v7
    v_add_u32 v8, 14336, v6
    v_add_u32 v9, 14336, v7
    s_lshl_b32 s58, s41, 17
    s_lshl_b32 s56, s40, 15
    s_add_u32 s58, s58, s56
    s_add_u32 s4, s64, s58
    s_addc_u32 s5, s65, 0
    s_and_b32 s5, s5, 0xffff
    s_mov_b32 s6, 32768
    s_mov_b32 s7, 0x20000
    s_add_u32 m0, s50, 0
    s_nop 0
    buffer_load_dwordx4 v6, s[4:7], s48 offen offset:0  lds
    buffer_load_dwordx4 v7, s[4:7], s48 offen offset:1024  lds
    buffer_load_dwordx4 v8, s[4:7], s48 offen offset:2048  lds
    buffer_load_dwordx4 v9, s[4:7], s48 offen offset:3072  lds
    v_add_u32 v125, 0, v120
    v_mul_u32_u24 v126, 171, v125
    v_lshrrev_b32 v126, 11, v126
    v_mul_u32_u24 v127, 12, v126
    v_sub_u32 v127, v125, v127
    v_mul_u32_u24 v126, 2752, v126
    v_cmp_gt_u32 vcc, s46, v127
    v_lshl_add_u32 v126, v127, 4, v126
    v_subrev_u32 v126, 0, v126
    v_cndmask_b32 v10, v128, v126, vcc
    v_add_u32 v125, 64, v120
    v_mul_u32_u24 v126, 171, v125
    v_lshrrev_b32 v126, 11, v126
    v_mul_u32_u24 v127, 12, v126
    v_sub_u32 v127, v125, v127
    v_mul_u32_u24 v126, 2752, v126
    v_cmp_gt_u32 vcc, s46, v127
    v_lshl_add_u32 v126, v127, 4, v126
    v_subrev_u32 v126, 1024, v126
    v_cndmask_b32 v11, v128, v126, vcc
    v_add_u32 v125, 128, v120
    v_mul_u32_u24 v126, 171, v125
    v_lshrrev_b32 v126, 11, v126
    v_mul_u32_u24 v127, 12, v126
    v_sub_u32 v127, v125, v127
    v_mul_u32_u24 v126, 2752, v126
    v_cmp_gt_u32 vcc, s46, v127
    v_lshl_add_u32 v126, v127, 4, v126
    v_subrev_u32 v126, 2048, v126
    v_cndmask_b32 v12, v128, v126, vcc
    s_mul_i32 s49, s48, 1376
    s_mul_i32 s58, s40, 44032
    s_add_u32 s59, s59, s58
    s_mul_i32 s54, s40, 3072
    s_add_u32 s54, s54, 65536
    s_add_u32 s20, s78, s59
    s_addc_u32 s21, s79, 0
    s_and_b32 s21, s21, 0xffff
    s_sub_u32 s22, 1409024, s59
    s_mov_b32 s23, 0x20000
    s_add_u32 m0, s54, 0
    s_nop 0
    buffer_load_dwordx4 v10, s[20:23], s49 offen offset:0  lds
    buffer_load_dwordx4 v11, s[20:23], s49 offen offset:1024  lds
    buffer_load_dwordx4 v12, s[20:23], s49 offen offset:2048  lds
    v_mov_b32 v28, 0
    v_mov_b32 v29, 0
    v_mov_b32 v30, 0
    v_mov_b32 v31, 0
    v_add_u32 v125, 162304, v1
    ds_write_b128 v125, v[28:31]
    v_mov_b32 v24, 157440
    ds_write_b128 v24, v[28:31]
    ds_write_b128 v24, v[28:31] offset:16
    ds_write_b128 v24, v[28:31] offset:32
    ds_write_b128 v24, v[28:31] offset:48
    s_lshl_b32 s56, s40, 2
    v_add_u32 v23, s56, v24
    v_mov_b32 v25, 1
    s_lshl_b32 s56, s44, 7
    s_lshl_b32 s57, s43, 2
    s_add_u32 s56, s56, s57
    s_load_dword s89, s[74:75], s56
    s_lshl_b32 s56, s44, 5
    s_add_u32 s56, s56, s43
    s_lshl_b32 s56, s56, 13
    s_lshl_b32 s57, s40, 11
    s_add_u32 s88, s56, s57
    s_lshl_b32 s56, s44, 11
    s_lshr_b32 s57, s43, 3
    s_lshl_b32 s57, s57, 9
    s_add_u32 s91, s56, s57
    s_add_u32 s91, s91, 14450688
    s_lshl_b32 s57, s40, 9
    s_add_u32 s56, s56, s57
    s_lshl_b32 s57, s43, 4
    s_add_u32 s56, s56, s57
    s_add_u32 s3, s56, 14467072
    s_lshl_b32 s57, s52, 11
    s_mul_i32 s62, s53, 4128
    s_add_u32 s62, s62, s57
    s_add_u32 s62, s62, 124448
    v_add_u32 v14, s62, v1
    v_and_b32_e64 v125, 1, v122
    v_mul_u32_u24 v21, 4128, v123
    v_lshl_add_u32 v21, v125, 4, v21
    v_add_u32 v21, 124416, v21
    ds_write_b128 v21, v[28:31]
    v_lshrrev_b32 v121, 5, v120
    v_and_b32 v126, 31, v120
    v_mul_u32_u24 v22, 4608, v121
    v_lshl_add_u32 v22, v126, 4, v22
    v_add_u32 v22, 115200, v22
    ds_write_b128 v22, v[28:31]
    s_mul_i32 s56, s53, 4608
    s_add_u32 s57, s56, s57
    s_add_u32 s57, s57, 115712
    v_add_u32 v15, s57, v1
    v_lshlrev_b32 v2, 4, v126
    s_lshl_b32 s57, s52, 8
    s_sub_u32 s56, s56, s57
    s_add_u32 s56, s56, 115488
    v_and_b32 v125, 15, v120
    v_lshlrev_b32 v126, 5, v125
    v_lshl_add_u32 v126, v124, 4, v126
    v_add_u32 v17, s56, v126
    v_and_b32 v126, 1, v124
    v_lshlrev_b32 v112, 2, v126
    v_and_b32 v127, 2, v124
    v_lshl_or_b32 v126, v127, 2, v126
    v_xor_b32 v125, v125, v126
    v_lshl_add_u32 v125, v124, 4, v125
    v_lshlrev_b32 v125, 4, v125
    s_lshl_b32 s56, s40, 13
    s_add_u32 s56, s56, 124416
    v_add_u32 v18, s56, v125
    v_xor_b32 v112, v112, v123
    v_lshlrev_b32_e64 v112, 4, v112
    v_lshl_add_u32 v112, v122, 10, v112
    v_add_u32 v113, 7168, v112
    v_add_u32 v114, 14336, v112
    v_add_u32 v115, 21504, v112
    v_lshrrev_b32 v125, 2, v120
    v_and_b32 v126, 1, v120
    v_and_b32 v127, 2, v120
    v_lshl_or_b32 v126, v127, 2, v126
    v_xor_b32 v125, v125, v126
    v_and_b32 v127, 3, v120
    v_lshl_add_u32 v125, v127, 4, v125
    v_lshlrev_b32 v125, 4, v125
    s_lshl_b32 s56, s40, 11
    s_add_u32 s56, s56, 124416
    v_add_u32 v19, s56, v125
    s_lshl_b32 s55, s40, 13
    s_lshl_b32 s56, s40, 10
    s_add_u32 s56, s56, 115712
    v_lshl_add_u32 v20, v120, 3, s56
    v_bfe_u32 v125, v120, 2, 2
    v_mul_u32_u24 v126, 8256, v125
    v_lshl_add_u32 v126, v124, 4, v126
    v_lshlrev_b32 v127, 3, v127
    v_sub_u32 v126, v127, v126
    s_mul_i32 s56, s53, 4128
    s_add_u32 s56, s56, s57
    s_add_u32 s56, s56, 149240
    v_add_u32 v16, s56, v126
    s_mul_i32 s56, s40, 360448
    s_lshl_b32 s57, s44, 7
    s_add_u32 s57, s56, s57
    s_add_u32 s24, s82, s57
    s_addc_u32 s25, s83, 0
    s_and_b32 s25, s25, 0xffff
    s_sub_u32 s26, 1409024, s57
    s_mov_b32 s27, 0x20000
    s_mov_b32 s8, s82
    s_and_b32 s9, s83, 0xffff
    s_mov_b32 s10, 1409024
    s_mov_b32 s11, 0x20000
    s_lshl_b32 s56, s2, 2
    s_add_u32 s56, s56, s40
    s_mul_i32 s56, s56, 1408
    v_min_u32 v5, 10, v120
    v_lshl_add_u32 v5, v5, 7, s56
    s_lshr_b32 s56, s2, 3
    s_lshl_b32 s56, s56, 2
    s_add_u32 s56, s56, s40
    s_mul_i32 s56, s56, 11264
    s_add_u32 s56, s56, 384
    v_and_b32 v125, 31, v120
    v_min_u32 v125, 10, v125
    v_lshl_add_u32 v125, v125, 10, s56
    v_mov_b32 v13, v125
    s_waitcnt lgkmcnt(0)
    s_and_b32 s90, s89, 0xffff0000
    s_lshl_b32 s89, s89, 16
    s_add_u32 s48, s48, 128
    s_and_b32 s48, s48, 1023
    s_mul_i32 s49, s48, 1376
    s_add_u32 m0, s50, 4096
    s_nop 0
    s_nop 0
    buffer_load_dwordx4 v6, s[4:7], s48 offen offset:0  lds
    buffer_load_dwordx4 v7, s[4:7], s48 offen offset:1024  lds
    buffer_load_dwordx4 v8, s[4:7], s48 offen offset:2048  lds
    buffer_load_dwordx4 v9, s[4:7], s48 offen offset:3072  lds
    s_add_u32 m0, s54, 12288
    s_nop 0
    buffer_load_dwordx4 v10, s[20:23], s49 offen offset:0  lds
    s_waitcnt vmcnt(12)
    s_barrier
    s_barrier
    ds_read_b32 v26, v24 offset:1280
    buffer_load_dwordx4 v11, s[20:23], s49 offen offset:1024  lds
    buffer_load_dwordx4 v12, s[20:23], s49 offen offset:2048  lds
    s_add_u32 s48, s48, 128
    s_and_b32 s48, s48, 1023
    s_mul_i32 s49, s48, 1376
    s_add_u32 m0, s50, 8192
    s_nop 0
    buffer_load_dwordx4 v6, s[4:7], s48 offen offset:0  lds
    s_waitcnt lgkmcnt(0)
    v_readfirstlane_b32 s47, v26
    s_nop 0
    s_add_u32 s47, s47, 2654435760
    s_and_b32 s47, s47, 0xfffffff0
    buffer_load_dwordx4 v7, s[4:7], s48 offen offset:1024  lds
    buffer_load_dwordx4 v8, s[4:7], s48 offen offset:2048  lds
    buffer_load_dwordx4 v9, s[4:7], s48 offen offset:3072  lds
    s_add_u32 m0, s54, 24576
    s_nop 0
    buffer_load_dwordx4 v10, s[20:23], s49 offen offset:0  lds
    s_waitcnt vmcnt(12)
    s_barrier
    buffer_load_dwordx4 v11, s[20:23], s49 offen offset:1024  lds
    buffer_load_dwordx4 v12, s[20:23], s49 offen offset:2048  lds
    s_add_u32 s48, s48, 128
    s_and_b32 s48, s48, 1023
    s_mul_i32 s49, s48, 1376
    s_add_u32 m0, s50, 12288
    s_nop 0
    buffer_load_dwordx4 v6, s[4:7], s48 offen offset:0  lds
    buffer_load_dwordx4 v7, s[4:7], s48 offen offset:1024  lds
    buffer_load_dwordx4 v8, s[4:7], s48 offen offset:2048  lds
    buffer_load_dwordx4 v9, s[4:7], s48 offen offset:3072  lds
    s_waitcnt vmcnt(11)
    s_barrier
    s_add_u32 m0, s54, 36864
    s_nop 0
    buffer_load_dwordx4 v10, s[20:23], s49 offen offset:0  lds
    buffer_load_dwordx4 v11, s[20:23], s49 offen offset:1024  lds
    buffer_load_dwordx4 v12, s[20:23], s49 offen offset:2048  lds
    s_add_u32 s48, s48, 128
    s_and_b32 s48, s48, 1023
    s_mul_i32 s49, s48, 1376
    s_add_u32 m0, s50, 0
    s_nop 0
    buffer_load_dwordx4 v6, s[4:7], s48 offen offset:0  lds
    buffer_load_dwordx4 v7, s[4:7], s48 offen offset:1024  lds
    buffer_load_dwordx4 v8, s[4:7], s48 offen offset:2048  lds
    buffer_load_dwordx4 v9, s[4:7], s48 offen offset:3072  lds
    s_add_u32 m0, s54, 0
    s_nop 0
    buffer_load_dwordx4 v10, s[20:23], s49 offen offset:0  lds
    buffer_load_dwordx4 v11, s[20:23], s49 offen offset:1024  lds
    buffer_load_dwordx4 v12, s[20:23], s49 offen offset:2048  lds
    s_waitcnt vmcnt(14)
    s_barrier
    s_add_u32 m0, s62, 24768
    s_nop 0
    s_nop 0
    buffer_load_dwordx4 v1, s[16:19], s88 offen nt lds
    buffer_load_dwordx4 v1, s[16:19], s88 offen offset:1024 nt lds
    buffer_load_dword v5, v5, s[8:11], 0 offen
    s_add_u32 s48, s48, 128
    s_and_b32 s48, s48, 1023
    s_mul_i32 s49, s48, 1376
    s_add_u32 m0, s50, 4096
    s_nop 0
    s_nop 0
    buffer_load_dwordx4 v6, s[4:7], s48 offen offset:0  lds
    buffer_load_dwordx4 v7, s[4:7], s48 offen offset:1024  lds
    buffer_load_dwordx4 v8, s[4:7], s48 offen offset:2048  lds
    buffer_load_dwordx4 v9, s[4:7], s48 offen offset:3072  lds
    s_add_u32 m0, s54, 12288
    s_nop 0
    buffer_load_dwordx4 v10, s[20:23], s49 offen offset:0  lds
    buffer_load_dwordx4 v11, s[20:23], s49 offen offset:1024  lds
    buffer_load_dwordx4 v12, s[20:23], s49 offen offset:2048  lds
    s_waitcnt vmcnt(17)
    s_barrier
    s_add_u32 s48, s48, 128
    s_and_b32 s48, s48, 1023
    s_mul_i32 s49, s48, 1376
    s_add_u32 m0, s50, 8192
    s_nop 0
    buffer_load_dwordx4 v6, s[4:7], s48 offen offset:0  lds
    buffer_load_dwordx4 v7, s[4:7], s48 offen offset:1024  lds
    buffer_load_dwordx4 v8, s[4:7], s48 offen offset:2048  lds
    buffer_load_dwordx4 v9, s[4:7], s48 offen offset:3072  lds
    s_add_u32 m0, s54, 24576
    s_nop 0
    buffer_load_dwordx4 v10, s[20:23], s49 offen offset:0  lds
    buffer_load_dwordx4 v11, s[20:23], s49 offen offset:1024  lds
    buffer_load_dwordx4 v12, s[20:23], s49 offen offset:2048  lds
    s_waitcnt vmcnt(17)
    s_barrier
    s_add_u32 s48, s48, 128
    s_and_b32 s48, s48, 1023
    s_mul_i32 s49, s48, 1376
    s_add_u32 m0, s50, 12288
    s_nop 0
    buffer_load_dwordx4 v6, s[4:7], s48 offen offset:0  lds
    buffer_load_dwordx4 v7, s[4:7], s48 offen offset:1024  lds
    buffer_load_dwordx4 v8, s[4:7], s48 offen offset:2048  lds
    buffer_load_dwordx4 v9, s[4:7], s48 offen offset:3072  lds
    s_add_u32 m0, s54, 36864
    s_nop 0
    buffer_load_dwordx4 v10, s[20:23], s49 offen offset:0  lds
    buffer_load_dwordx4 v11, s[20:23], s49 offen offset:1024  lds
    buffer_load_dwordx4 v12, s[20:23], s49 offen offset:2048  lds
    s_waitcnt vmcnt(14)
    s_barrier
    buffer_load_dword v27, v2, s[28:31], s91 offen sc1
    buffer_load_dword v13, v13, s[8:11], 0 offen
    s_mov_b32 s97, 0
    s_add_u32 m0, s50, 0
    s_nop 0
    buffer_load_dwordx4 v112, s[24:27], s97 offen offset:0 lds
    buffer_load_dwordx4 v113, s[24:27], s97 offen offset:1024 lds
    buffer_load_dwordx4 v114, s[24:27], s97 offen offset:2048 lds
    buffer_load_dwordx4 v115, s[24:27], s97 offen offset:3072 lds
    s_waitcnt vmcnt(13)
    s_barrier
    s_mov_b32 s97, 98304
    s_add_u32 m0, s50, 4096
    s_nop 0
    buffer_load_dwordx4 v112, s[24:27], s97 offen offset:0 lds
    buffer_load_dwordx4 v113, s[24:27], s97 offen offset:1024 lds
    buffer_load_dwordx4 v114, s[24:27], s97 offen offset:2048 lds
    buffer_load_dwordx4 v115, s[24:27], s97 offen offset:3072 lds
    s_waitcnt vmcnt(10)
    s_barrier
    s_mov_b32 s97, 196608
    s_add_u32 m0, s50, 8192
    s_nop 0
    buffer_load_dwordx4 v112, s[24:27], s97 offen offset:0 lds
    buffer_load_dwordx4 v113, s[24:27], s97 offen offset:1024 lds
    buffer_load_dwordx4 v114, s[24:27], s97 offen offset:2048 lds
    buffer_load_dwordx4 v115, s[24:27], s97 offen offset:3072 lds
    s_mov_b32 s97, 294912
    s_add_u32 m0, s55, 65536
    s_nop 0
    s_nop 0
    buffer_load_dwordx4 v112, s[24:27], s97 offen offset:0 lds
    buffer_load_dwordx4 v113, s[24:27], s97 offen offset:1024 lds
    buffer_load_dwordx4 v114, s[24:27], s97 offen offset:2048 lds
    buffer_load_dwordx4 v115, s[24:27], s97 offen offset:3072 lds
    s_mov_b32 s97, 32768
    s_add_u32 m0, s55, 69632
    s_nop 0
    buffer_load_dwordx4 v112, s[24:27], s97 offen offset:0 lds
    buffer_load_dwordx4 v113, s[24:27], s97 offen offset:1024 lds
    buffer_load_dwordx4 v114, s[24:27], s97 offen offset:2048 lds
    buffer_load_dwordx4 v115, s[24:27], s97 offen offset:3072 lds
    s_barrier
    s_setprio 3
    s_mov_b32 s97, 131072
    s_add_u32 m0, s50, 12288
    s_nop 0
    buffer_load_dwordx4 v112, s[24:27], s97 offen offset:0 lds
    s_waitcnt vmcnt(22)
    s_mov_b32 s60, 0
L_f1:
    v_cmp_ne_u32 vcc, s47, v27
    s_nop 0
    s_and_b64 vcc, vcc, -1
    s_cbranch_scc0 L_f1_ok
    s_sleep 8
    buffer_load_dword v27, v2, s[28:31], s91 offen sc1
    s_add_u32 s60, s60, 1
    s_cmp_lt_u32 s60, 32768
    s_waitcnt vmcnt(0)
    s_cbranch_scc1 L_f1
L_f1_ok:
    buffer_load_dwordx4 v[104:107], v1, s[28:31], s88 offen offset:0 sc1
    buffer_load_dwordx4 v[108:111], v1, s[28:31], s88 offen offset:1024 sc1
    buffer_load_dwordx4 v113, s[24:27], s97 offen offset:1024 lds
    buffer_load_dwordx4 v114, s[24:27], s97 offen offset:2048 lds
    buffer_load_dwordx4 v115, s[24:27], s97 offen offset:3072 lds
    ds_read_b64 v[64:65], v14 offset:24760
    ds_read_b128 v[66:69], v14 offset:24768
    ds_read_b64 v[72:73], v14 offset:25784
    ds_read_b128 v[74:77], v14 offset:25792
    s_waitcnt lgkmcnt(0)
    v_alignbit_b32 v80, v66, v65, 16
    v_mov_b32 v84, v65
    v_alignbit_b32 v88, v65, v64, 16
    v_alignbit_b32 v81, v67, v66, 16
    v_mov_b32_e64 v85, v66
    v_alignbit_b32 v89, v66, v65, 16
    v_alignbit_b32 v82, v68, v67, 16
    v_mov_b32_e64 v86, v67
    v_alignbit_b32 v90, v67, v66, 16
    v_alignbit_b32 v83, v69, v68, 16
    v_mov_b32_e64 v87, v68
    v_alignbit_b32 v91, v68, v67, 16
    ds_write_b128 v14, v[80:83] offset:16512
    ds_write_b128 v14, v[84:87] offset:8256
    ds_write_b128 v14, v[88:91] offset:0
    v_alignbit_b32 v92, v74, v73, 16
    v_mov_b32_e64 v96, v73
    v_alignbit_b32 v100, v73, v72, 16
    v_alignbit_b32 v93, v75, v74, 16
    v_mov_b32_e64 v97, v74
    v_alignbit_b32 v101, v74, v73, 16
    v_alignbit_b32 v94, v76, v75, 16
    v_mov_b32_e64 v98, v75
    v_alignbit_b32 v102, v75, v74, 16
    v_alignbit_b32 v95, v77, v76, 16
    v_mov_b32_e64 v99, v76
    v_alignbit_b32 v103, v76, v75, 16
    ds_write_b128 v14, v[92:95] offset:17536
    ds_write_b128 v14, v[96:99] offset:9280
    ds_write_b128 v14, v[100:103] offset:1024
    s_lshl_b32 s56, s40, 2
    v_add_u32 v27, s56, v24
    s_waitcnt vmcnt(3)
    ds_write_b128 v15, v[104:107] offset:0
    ds_write_b128 v15, v[108:111] offset:1024
    s_waitcnt lgkmcnt(0)
    s_waitcnt lgkmcnt(0)
    s_mov_b64 exec, 1
    ds_add_u32 v24, v25 offset:0
    s_mov_b64 exec, -1
    s_mov_b32 s60, 0
L_vs0:
    ds_read_b32 v26, v24 offset:0
    s_add_u32 s60, s60, 1
    s_waitcnt lgkmcnt(0)
    v_cmp_ne_u32 vcc, 4, v26
    s_cbranch_vccz L_vs0_ok
    s_cmp_lt_u32 s60, 0x40000
    s_cbranch_scc1 L_vs0
L_vs0_ok:
    s_nop 0
    ds_read_b128 a[64:67], v17 offset:192
    ds_read_b64_tr_b16 a[0:1], v16 offset:8
    ds_read_b64_tr_b16 a[2:3], v16 offset:0
    ds_read_b128 a[68:71], v17 offset:704
    ds_read_b64_tr_b16 a[4:5], v16 offset:520
    ds_read_b64_tr_b16 a[6:7], v16 offset:512
    ds_read_b128 a[72:75], v17 offset:1216
    ds_read_b64_tr_b16 a[8:9], v16 offset:1032
    ds_read_b64_tr_b16 a[10:11], v16 offset:1024
    ds_read_b128 a[76:79], v17 offset:1728
    ds_read_b64_tr_b16 a[12:13], v16 offset:1544
    ds_read_b64_tr_b16 a[14:15], v16 offset:1536
    ds_read_b128 a[80:83], v17 offset:2240
    ds_read_b64_tr_b16 a[16:17], v16 offset:2056
    ds_read_b64_tr_b16 a[18:19], v16 offset:2048
    ds_read_b128 a[84:87], v17 offset:2752
    ds_read_b64_tr_b16 a[20:21], v16 offset:2568
    ds_read_b64_tr_b16 a[22:23], v16 offset:2560
    ds_read_b128 a[88:91], v17 offset:3264
    ds_read_b64_tr_b16 a[24:25], v16 offset:3080
    ds_read_b64_tr_b16 a[26:27], v16 offset:3072
    ds_read_b128 a[92:95], v17 offset:3776
    ds_read_b64_tr_b16 a[28:29], v16 offset:3592
    ds_read_b64_tr_b16 a[30:31], v16 offset:3584
    s_waitcnt vmcnt(0)
    ds_write_b32 v27, v25 offset:16
    s_mov_b32 s60, 0
L_vg:
    ds_read_b32 v26, v27 offset:32
    s_add_u32 s60, s60, 1
    s_waitcnt lgkmcnt(0)
    v_cmp_eq_u32 vcc, 0, v26
    s_cbranch_vccz L_vg_ok
    s_sleep 1
    s_cmp_lt_u32 s60, 0x40000
    s_cbranch_scc1 L_vg
L_vg_ok:
    s_setprio 1
    v_mfma_f32_16x16x32_bf16 v[32:35], a[0:3], a[64:67], 0
    v_mfma_f32_16x16x32_bf16 v[36:39], a[0:3], a[68:71], 0
    v_mfma_f32_16x16x32_bf16 v[36:39], a[4:7], a[64:67], v[36:39]
    v_mfma_f32_16x16x32_bf16 v[40:43], a[4:7], a[68:71], 0
    v_mfma_f32_16x16x32_bf16 v[40:43], a[0:3], a[72:75], v[40:43]
    v_mfma_f32_16x16x32_bf16 v[44:47], a[4:7], a[72:75], 0
    v_mfma_f32_16x16x32_bf16 v[40:43], a[8:11], a[64:67], v[40:43]
    v_mfma_f32_16x16x32_bf16 v[44:47], a[8:11], a[68:71], v[44:47]
    v_mfma_f32_16x16x32_bf16 v[48:51], a[8:11], a[72:75], 0
    ds_read_b128 v[64:67], v17 offset:128
    v_mfma_f32_16x16x32_bf16 v[44:47], a[0:3], a[76:79], v[44:47]
    ds_read_b64_tr_b16 a[32:33], v16 offset:72
    v_mfma_f32_16x16x32_bf16 v[48:51], a[4:7], a[76:79], v[48:51]
    ds_read_b64_tr_b16 a[34:35], v16 offset:64
    v_mfma_f32_16x16x32_bf16 v[52:55], a[8:11], a[76:79], 0
    ds_read_b128 v[68:71], v17 offset:640
    v_mfma_f32_16x16x32_bf16 v[44:47], a[12:15], a[64:67], v[44:47]
    ds_read_b64_tr_b16 a[36:37], v16 offset:584
    v_mfma_f32_16x16x32_bf16 v[48:51], a[12:15], a[68:71], v[48:51]
    ds_read_b64_tr_b16 a[38:39], v16 offset:576
    v_mfma_f32_16x16x32_bf16 v[52:55], a[12:15], a[72:75], v[52:55]
    ds_read_b128 v[72:75], v17 offset:1152
    v_mfma_f32_16x16x32_bf16 v[56:59], a[12:15], a[76:79], 0
    ds_read_b64_tr_b16 a[40:41], v16 offset:1096
    v_mfma_f32_16x16x32_bf16 v[48:51], a[0:3], a[80:83], v[48:51]
    ds_read_b64_tr_b16 a[42:43], v16 offset:1088
    v_mfma_f32_16x16x32_bf16 v[52:55], a[4:7], a[80:83], v[52:55]
    ds_read_b128 v[76:79], v17 offset:1664
    v_mfma_f32_16x16x32_bf16 v[56:59], a[8:11], a[80:83], v[56:59]
    ds_read_b64_tr_b16 a[44:45], v16 offset:1608
    v_mfma_f32_16x16x32_bf16 v[60:63], a[12:15], a[80:83], 0
    ds_read_b64_tr_b16 a[46:47], v16 offset:1600
    v_mfma_f32_16x16x32_bf16 v[48:51], a[16:19], a[64:67], v[48:51]
    ds_read_b128 v[80:83], v17 offset:2176
    v_mfma_f32_16x16x32_bf16 v[52:55], a[16:19], a[68:71], v[52:55]
    ds_read_b64_tr_b16 a[48:49], v16 offset:2120
    v_mfma_f32_16x16x32_bf16 v[56:59], a[16:19], a[72:75], v[56:59]
    ds_read_b64_tr_b16 a[50:51], v16 offset:2112
    v_mfma_f32_16x16x32_bf16 v[60:63], a[16:19], a[76:79], v[60:63]
    ds_read_b128 v[84:87], v17 offset:2688
    v_mfma_f32_16x16x32_bf16 v[52:55], a[0:3], a[84:87], v[52:55]
    ds_read_b64_tr_b16 a[52:53], v16 offset:2632
    v_mfma_f32_16x16x32_bf16 v[56:59], a[4:7], a[84:87], v[56:59]
    ds_read_b64_tr_b16 a[54:55], v16 offset:2624
    v_mfma_f32_16x16x32_bf16 v[60:63], a[8:11], a[84:87], v[60:63]
    ds_read_b128 v[88:91], v17 offset:3200
    v_mfma_f32_16x16x32_bf16 v[52:55], a[20:23], a[64:67], v[52:55]
    ds_read_b64_tr_b16 a[56:57], v16 offset:3144
    v_mfma_f32_16x16x32_bf16 v[56:59], a[20:23], a[68:71], v[56:59]
    ds_read_b64_tr_b16 a[58:59], v16 offset:3136
    v_mfma_f32_16x16x32_bf16 v[60:63], a[20:23], a[72:75], v[60:63]
    ds_read_b128 v[92:95], v17 offset:3712
    v_mfma_f32_16x16x32_bf16 v[56:59], a[0:3], a[88:91], v[56:59]
    ds_read_b64_tr_b16 a[60:61], v16 offset:3656
    v_mfma_f32_16x16x32_bf16 v[60:63], a[4:7], a[88:91], v[60:63]
    ds_read_b64_tr_b16 a[62:63], v16 offset:3648
    v_mfma_f32_16x16x32_bf16 v[56:59], a[24:27], a[64:67], v[56:59]
    v_mfma_f32_16x16x32_bf16 v[60:63], a[24:27], a[68:71], v[60:63]
    v_mfma_f32_16x16x32_bf16 v[60:63], a[0:3], a[92:95], v[60:63]
    v_mfma_f32_16x16x32_bf16 v[60:63], a[28:31], a[64:67], v[60:63]
    s_waitcnt lgkmcnt(0)
    v_mfma_f32_16x16x32_bf16 v[32:35], a[32:35], v[64:67], v[32:35]
    ds_read_b128 a[64:67], v17 offset:64
    v_mfma_f32_16x16x32_bf16 v[36:39], a[32:35], v[68:71], v[36:39]
    ds_read_b64_tr_b16 a[0:1], v16 offset:136
    v_mfma_f32_16x16x32_bf16 v[36:39], a[36:39], v[64:67], v[36:39]
    ds_read_b64_tr_b16 a[2:3], v16 offset:128
    v_mfma_f32_16x16x32_bf16 v[40:43], a[36:39], v[68:71], v[40:43]
    ds_read_b128 a[68:71], v17 offset:576
    v_mfma_f32_16x16x32_bf16 v[40:43], a[32:35], v[72:75], v[40:43]
    ds_read_b64_tr_b16 a[4:5], v16 offset:648
    v_mfma_f32_16x16x32_bf16 v[44:47], a[36:39], v[72:75], v[44:47]
    ds_read_b64_tr_b16 a[6:7], v16 offset:640
    v_mfma_f32_16x16x32_bf16 v[40:43], a[40:43], v[64:67], v[40:43]
    ds_read_b128 a[72:75], v17 offset:1088
    v_mfma_f32_16x16x32_bf16 v[44:47], a[40:43], v[68:71], v[44:47]
    ds_read_b64_tr_b16 a[8:9], v16 offset:1160
    v_mfma_f32_16x16x32_bf16 v[48:51], a[40:43], v[72:75], v[48:51]
    ds_read_b64_tr_b16 a[10:11], v16 offset:1152
    v_mfma_f32_16x16x32_bf16 v[44:47], a[32:35], v[76:79], v[44:47]
    ds_read_b128 a[76:79], v17 offset:1600
    v_mfma_f32_16x16x32_bf16 v[48:51], a[36:39], v[76:79], v[48:51]
    ds_read_b64_tr_b16 a[12:13], v16 offset:1672
    v_mfma_f32_16x16x32_bf16 v[52:55], a[40:43], v[76:79], v[52:55]
    ds_read_b64_tr_b16 a[14:15], v16 offset:1664
    v_mfma_f32_16x16x32_bf16 v[44:47], a[44:47], v[64:67], v[44:47]
    ds_read_b128 a[80:83], v17 offset:2112
    v_mfma_f32_16x16x32_bf16 v[48:51], a[44:47], v[68:71], v[48:51]
    ds_read_b64_tr_b16 a[16:17], v16 offset:2184
    v_mfma_f32_16x16x32_bf16 v[52:55], a[44:47], v[72:75], v[52:55]
    ds_read_b64_tr_b16 a[18:19], v16 offset:2176
    v_mfma_f32_16x16x32_bf16 v[56:59], a[44:47], v[76:79], v[56:59]
    ds_read_b128 a[84:87], v17 offset:2624
    v_mfma_f32_16x16x32_bf16 v[48:51], a[32:35], v[80:83], v[48:51]
    ds_read_b64_tr_b16 a[20:21], v16 offset:2696
    v_mfma_f32_16x16x32_bf16 v[52:55], a[36:39], v[80:83], v[52:55]
    ds_read_b64_tr_b16 a[22:23], v16 offset:2688
    v_mfma_f32_16x16x32_bf16 v[56:59], a[40:43], v[80:83], v[56:59]
    ds_read_b128 a[88:91], v17 offset:3136
    v_mfma_f32_16x16x32_bf16 v[60:63], a[44:47], v[80:83], v[60:63]
    ds_read_b64_tr_b16 a[24:25], v16 offset:3208
    v_mfma_f32_16x16x32_bf16 v[48:51], a[48:51], v[64:67], v[48:51]
    ds_read_b64_tr_b16 a[26:27], v16 offset:3200
    v_mfma_f32_16x16x32_bf16 v[52:55], a[48:51], v[68:71], v[52:55]
    ds_read_b128 a[92:95], v17 offset:3648
    v_mfma_f32_16x16x32_bf16 v[56:59], a[48:51], v[72:75], v[56:59]
    ds_read_b64_tr_b16 a[28:29], v16 offset:3720
    v_mfma_f32_16x16x32_bf16 v[60:63], a[48:51], v[76:79], v[60:63]
    ds_read_b64_tr_b16 a[30:31], v16 offset:3712
    v_mfma_f32_16x16x32_bf16 v[52:55], a[32:35], v[84:87], v[52:55]
    v_mfma_f32_16x16x32_bf16 v[56:59], a[36:39], v[84:87], v[56:59]
    v_mfma_f32_16x16x32_bf16 v[60:63], a[40:43], v[84:87], v[60:63]
    ds_read_b64 v[96:97], v20 offset:0
    v_mfma_f32_16x16x32_bf16 v[52:55], a[52:55], v[64:67], v[52:55]
    ds_read_b64 v[98:99], v20 offset:4608
    v_mfma_f32_16x16x32_bf16 v[56:59], a[52:55], v[68:71], v[56:59]
    ds_read_b64 v[100:101], v20 offset:512
    v_mfma_f32_16x16x32_bf16 v[60:63], a[52:55], v[72:75], v[60:63]
    ds_read_b64 v[102:103], v20 offset:5120
    v_mfma_f32_16x16x32_bf16 v[56:59], a[32:35], v[88:91], v[56:59]
    v_mfma_f32_16x16x32_bf16 v[60:63], a[36:39], v[88:91], v[60:63]
    v_mfma_f32_16x16x32_bf16 v[56:59], a[56:59], v[64:67], v[56:59]
    v_mfma_f32_16x16x32_bf16 v[60:63], a[56:59], v[68:71], v[60:63]
    v_mfma_f32_16x16x32_bf16 v[60:63], a[32:35], v[92:95], v[60:63]
    v_mfma_f32_16x16x32_bf16 v[60:63], a[60:63], v[64:67], v[60:63]
    s_waitcnt lgkmcnt(4)
    v_mfma_f32_16x16x32_bf16 v[32:35], a[0:3], a[64:67], v[32:35]
    ds_read_b128 v[64:67], v17 offset:0
    v_mfma_f32_16x16x32_bf16 v[36:39], a[0:3], a[68:71], v[36:39]
    ds_read_b64_tr_b16 a[32:33], v16 offset:200
    v_mfma_f32_16x16x32_bf16 v[36:39], a[4:7], a[64:67], v[36:39]
    ds_read_b64_tr_b16 a[34:35], v16 offset:192
    v_mfma_f32_16x16x32_bf16 v[40:43], a[4:7], a[68:71], v[40:43]
    ds_read_b128 v[68:71], v17 offset:512
    v_mfma_f32_16x16x32_bf16 v[40:43], a[0:3], a[72:75], v[40:43]
    ds_read_b64_tr_b16 a[36:37], v16 offset:712
    v_mfma_f32_16x16x32_bf16 v[44:47], a[4:7], a[72:75], v[44:47]
    ds_read_b64_tr_b16 a[38:39], v16 offset:704
    v_mfma_f32_16x16x32_bf16 v[40:43], a[8:11], a[64:67], v[40:43]
    ds_read_b128 v[72:75], v17 offset:1024
    v_mfma_f32_16x16x32_bf16 v[44:47], a[8:11], a[68:71], v[44:47]
    ds_read_b64_tr_b16 a[40:41], v16 offset:1224
    v_mfma_f32_16x16x32_bf16 v[48:51], a[8:11], a[72:75], v[48:51]
    ds_read_b64_tr_b16 a[42:43], v16 offset:1216
    v_mfma_f32_16x16x32_bf16 v[44:47], a[0:3], a[76:79], v[44:47]
    ds_read_b128 v[76:79], v17 offset:1536
    v_mfma_f32_16x16x32_bf16 v[48:51], a[4:7], a[76:79], v[48:51]
    ds_read_b64_tr_b16 a[44:45], v16 offset:1736
    v_mfma_f32_16x16x32_bf16 v[52:55], a[8:11], a[76:79], v[52:55]
    ds_read_b64_tr_b16 a[46:47], v16 offset:1728
    v_mfma_f32_16x16x32_bf16 v[44:47], a[12:15], a[64:67], v[44:47]
    ds_read_b128 v[80:83], v17 offset:2048
    v_mfma_f32_16x16x32_bf16 v[48:51], a[12:15], a[68:71], v[48:51]
    ds_read_b64_tr_b16 a[48:49], v16 offset:2248
    v_mfma_f32_16x16x32_bf16 v[52:55], a[12:15], a[72:75], v[52:55]
    ds_read_b64_tr_b16 a[50:51], v16 offset:2240
    v_mfma_f32_16x16x32_bf16 v[56:59], a[12:15], a[76:79], v[56:59]
    ds_read_b128 v[84:87], v17 offset:2560
    v_mfma_f32_16x16x32_bf16 v[48:51], a[0:3], a[80:83], v[48:51]
    ds_read_b64_tr_b16 a[52:53], v16 offset:2760
    v_mfma_f32_16x16x32_bf16 v[52:55], a[4:7], a[80:83], v[52:55]
    ds_read_b64_tr_b16 a[54:55], v16 offset:2752
    v_mfma_f32_16x16x32_bf16 v[56:59], a[8:11], a[80:83], v[56:59]
    ds_read_b128 v[88:91], v17 offset:3072
    v_mfma_f32_16x16x32_bf16 v[60:63], a[12:15], a[80:83], v[60:63]
    ds_read_b64_tr_b16 a[56:57], v16 offset:3272
    v_mfma_f32_16x16x32_bf16 v[48:51], a[16:19], a[64:67], v[48:51]
    ds_read_b64_tr_b16 a[58:59], v16 offset:3264
    v_mfma_f32_16x16x32_bf16 v[52:55], a[16:19], a[68:71], v[52:55]
    ds_read_b128 v[92:95], v17 offset:3584
    v_mfma_f32_16x16x32_bf16 v[56:59], a[16:19], a[72:75], v[56:59]
    ds_read_b64_tr_b16 a[60:61], v16 offset:3784
    v_mfma_f32_16x16x32_bf16 v[60:63], a[16:19], a[76:79], v[60:63]
    ds_read_b64_tr_b16 a[62:63], v16 offset:3776
    v_mfma_f32_16x16x32_bf16 v[52:55], a[0:3], a[84:87], v[52:55]
    v_mfma_f32_16x16x32_bf16 v[56:59], a[4:7], a[84:87], v[56:59]
    v_mfma_f32_16x16x32_bf16 v[60:63], a[8:11], a[84:87], v[60:63]
    s_waitcnt lgkmcnt(15)
    v_lshlrev_b32 v104, 16, v96
    v_and_b32 v105, s96, v96
    v_mfma_f32_16x16x32_bf16 v[52:55], a[20:23], a[64:67], v[52:55]
    v_lshlrev_b32 v106, 16, v97
    v_and_b32 v107, s96, v97
    v_mfma_f32_16x16x32_bf16 v[56:59], a[20:23], a[68:71], v[56:59]
    v_lshlrev_b32 v108, 16, v98
    v_and_b32 v109, s96, v98
    v_mfma_f32_16x16x32_bf16 v[60:63], a[20:23], a[72:75], v[60:63]
    v_lshlrev_b32 v110, 16, v99
    v_and_b32 v111, s96, v99
    v_mfma_f32_16x16x32_bf16 v[56:59], a[0:3], a[88:91], v[56:59]
    v_lshlrev_b32 v112, 16, v100
    v_and_b32 v113, s96, v100
    v_mfma_f32_16x16x32_bf16 v[60:63], a[4:7], a[88:91], v[60:63]
    v_lshlrev_b32 v114, 16, v101
    v_and_b32 v115, s96, v101
    v_mfma_f32_16x16x32_bf16 v[56:59], a[24:27], a[64:67], v[56:59]
    v_lshlrev_b32 v116, 16, v102
    v_and_b32 v117, s96, v102
    v_mfma_f32_16x16x32_bf16 v[60:63], a[24:27], a[68:71], v[60:63]
    v_lshlrev_b32 v118, 16, v103
    v_and_b32 v119, s96, v103
    v_mfma_f32_16x16x32_bf16 v[60:63], a[0:3], a[92:95], v[60:63]
    v_mfma_f32_16x16x32_bf16 v[60:63], a[28:31], a[64:67], v[60:63]
    s_waitcnt lgkmcnt(0)
    v_mfma_f32_16x16x32_bf16 v[32:35], a[32:35], v[64:67], v[32:35]
    s_waitcnt lgkmcnt(0)
    s_mov_b64 exec, 1
    ds_add_u32 v24, v25 offset:4
    s_mov_b64 exec, -1
    v_mfma_f32_16x16x32_bf16 v[36:39], a[32:35], v[68:71], v[36:39]
    v_mfma_f32_16x16x32_bf16 v[36:39], a[36:39], v[64:67], v[36:39]
    v_mfma_f32_16x16x32_bf16 v[40:43], a[32:35], v[72:75], v[40:43]
    v_mfma_f32_16x16x32_bf16 v[40:43], a[36:39], v[68:71], v[40:43]
    v_mfma_f32_16x16x32_bf16 v[40:43], a[40:43], v[64:67], v[40:43]
    v_mfma_f32_16x16x32_bf16 v[44:47], a[32:35], v[76:79], v[44:47]
    ds_read_b32 v26, v24 offset:4
    v_mfma_f32_16x16x32_bf16 v[44:47], a[36:39], v[72:75], v[44:47]
    v_mfma_f32_16x16x32_bf16 v[44:47], a[40:43], v[68:71], v[44:47]
    v_mfma_f32_16x16x32_bf16 v[44:47], a[44:47], v[64:67], v[44:47]
    v_mfma_f32_16x16x32_bf16 v[48:51], a[32:35], v[80:83], v[48:51]
    v_mfma_f32_16x16x32_bf16 v[48:51], a[36:39], v[76:79], v[48:51]
    v_mfma_f32_16x16x32_bf16 v[48:51], a[40:43], v[72:75], v[48:51]
    v_mfma_f32_16x16x32_bf16 v[48:51], a[44:47], v[68:71], v[48:51]
    s_waitcnt lgkmcnt(0)
    s_mov_b32 s60, 0
L_vs1:
    v_cmp_ne_u32 vcc, 4, v26
    s_cbranch_vccz L_vs1_ok
    ds_read_b32 v26, v24 offset:4
    s_add_u32 s60, s60, 1
    s_waitcnt lgkmcnt(0)
    s_cmp_lt_u32 s60, 0x40000
    s_cbranch_scc1 L_vs1
L_vs1_ok:
    v_mfma_f32_16x16x32_bf16 v[48:51], a[48:51], v[64:67], v[48:51]
    v_mfma_f32_16x16x32_bf16 v[52:55], a[32:35], v[84:87], v[52:55]
    ds_write_b128 v18, v[32:35] offset:0
    v_mfma_f32_16x16x32_bf16 v[52:55], a[36:39], v[80:83], v[52:55]
    v_mfma_f32_16x16x32_bf16 v[52:55], a[40:43], v[76:79], v[52:55]
    ds_write_b128 v18, v[36:39] offset:1024
    v_mfma_f32_16x16x32_bf16 v[52:55], a[44:47], v[72:75], v[52:55]
    v_mfma_f32_16x16x32_bf16 v[52:55], a[48:51], v[68:71], v[52:55]
    ds_write_b128 v18, v[40:43] offset:2048
    v_mfma_f32_16x16x32_bf16 v[52:55], a[52:55], v[64:67], v[52:55]
    v_mfma_f32_16x16x32_bf16 v[56:59], a[32:35], v[88:91], v[56:59]
    ds_write_b128 v18, v[44:47] offset:3072
    v_mfma_f32_16x16x32_bf16 v[56:59], a[36:39], v[84:87], v[56:59]
    v_mfma_f32_16x16x32_bf16 v[56:59], a[40:43], v[80:83], v[56:59]
    ds_write_b128 v18, v[48:51] offset:4096
    v_mfma_f32_16x16x32_bf16 v[56:59], a[44:47], v[76:79], v[56:59]
    v_mfma_f32_16x16x32_bf16 v[56:59], a[48:51], v[72:75], v[56:59]
    v_mfma_f32_16x16x32_bf16 v[56:59], a[52:55], v[68:71], v[56:59]
    v_mfma_f32_16x16x32_bf16 v[56:59], a[56:59], v[64:67], v[56:59]
    ds_write_b128 v18, v[52:55] offset:5120
    v_mfma_f32_16x16x32_bf16 v[60:63], a[32:35], v[92:95], v[60:63]
    v_mfma_f32_16x16x32_bf16 v[60:63], a[36:39], v[88:91], v[60:63]
    v_mfma_f32_16x16x32_bf16 v[60:63], a[40:43], v[84:87], v[60:63]
    v_mfma_f32_16x16x32_bf16 v[60:63], a[44:47], v[80:83], v[60:63]
    v_mfma_f32_16x16x32_bf16 v[60:63], a[48:51], v[76:79], v[60:63]
    v_mfma_f32_16x16x32_bf16 v[60:63], a[52:55], v[72:75], v[60:63]
    v_mfma_f32_16x16x32_bf16 v[60:63], a[56:59], v[68:71], v[60:63]
    ds_write_b128 v18, v[56:59] offset:6144
    v_mfma_f32_16x16x32_bf16 v[60:63], a[60:63], v[64:67], v[60:63]
    s_nop 7
    ds_write_b128 v18, v[60:63] offset:7168
    s_waitcnt lgkmcnt(0)
    s_mov_b64 exec, 1
    ds_add_u32 v24, v25 offset:8
    s_mov_b64 exec, -1
    s_mov_b32 s60, 0
L_vs2:
    ds_read_b32 v26, v24 offset:8
    s_add_u32 s60, s60, 1
    s_waitcnt lgkmcnt(0)
    v_cmp_ne_u32 vcc, 4, v26
    s_cbranch_vccz L_vs2_ok
    s_cmp_lt_u32 s60, 0x40000
    s_cbranch_scc1 L_vs2
L_vs2_ok:
    s_nop 0
    ds_read_b128 v[64:67], v19 offset:0
    ds_read_b128 v[68:71], v19 offset:8192
    ds_read_b128 v[72:75], v19 offset:16384
    ds_read_b128 v[76:79], v19 offset:24576
    ds_read_b128 v[80:83], v19 offset:1024
    ds_read_b128 v[84:87], v19 offset:9216
    ds_read_b128 v[88:91], v19 offset:17408
    ds_read_b128 v[92:95], v19 offset:25600
    s_waitcnt lgkmcnt(4)
    v_add_f32 v64, v64, v68
    v_add_f32 v65, v65, v69
    v_add_f32 v66, v66, v70
    v_add_f32_e64 v67, v67, v71
    v_fma_f32 v64, v104, s89, v64
    v_fma_f32 v65, v105, s89, v65
    v_fma_f32 v66, v106, s89, v66
    v_fma_f32 v67, v107, s89, v67
    v_add_f32 v72, v72, v76
    v_add_f32 v73, v73, v77
    v_add_f32 v74, v74, v78
    v_add_f32 v75, v75, v79
    v_fma_f32 v72, v108, s90, v72
    v_fma_f32 v73, v109, s90, v73
    v_fma_f32 v74, v110, s90, v74
    v_fma_f32 v75, v111, s90, v75
    v_cvt_pk_bf16_f32 v120, v64, v72
    v_cvt_pk_bf16_f32 v121, v65, v73
    v_cvt_pk_bf16_f32 v122, v66, v74
    v_cvt_pk_bf16_f32 v123, v67, v75
    buffer_store_dwordx4 v[120:123], v1, s[28:31], s88 offen offset:0 sc1
    s_waitcnt lgkmcnt(0)
    v_add_f32 v80, v80, v84
    v_add_f32 v81, v81, v85
    v_add_f32 v82, v82, v86
    v_add_f32_e64 v83, v83, v87
    v_fma_f32 v80, v112, s89, v80
    v_fma_f32 v81, v113, s89, v81
    v_fma_f32 v82, v114, s89, v82
    v_fma_f32 v83, v115, s89, v83
    v_add_f32 v88, v88, v92
    v_add_f32 v89, v89, v93
    v_add_f32 v90, v90, v94
    v_add_f32 v91, v91, v95
    v_fma_f32 v88, v116, s90, v88
    v_fma_f32 v89, v117, s90, v89
    v_fma_f32 v90, v118, s90, v90
    v_fma_f32 v91, v119, s90, v91
    v_cvt_pk_bf16_f32 v124, v80, v88
    v_cvt_pk_bf16_f32 v125, v81, v89
    v_cvt_pk_bf16_f32 v126, v82, v90
    v_cvt_pk_bf16_f32 v127, v83, v91
    buffer_store_dwordx4 v[124:127], v1, s[28:31], s88 offen offset:1024 sc1
    v_mov_b32 v26, s47
    s_waitcnt vmcnt(0)
    s_mov_b64 exec, 1
    buffer_store_dword v26, v3, s[28:31], s3 offen sc1
    s_mov_b64 exec, -1
    s_or_b32 s56, s2, s40
    s_cmp_lg_u32 s56, 0
    s_cbranch_scc1 L_noep
    s_nop 0
    s_mov_b32 s57, 14422016
    buffer_load_dword v64, v1, s[28:31], s57 offen offset:0 sc1
    buffer_load_dword v65, v1, s[28:31], s57 offen offset:1024 sc1
    buffer_load_dword v66, v1, s[28:31], s57 offen offset:2048 sc1
    buffer_load_dword v67, v1, s[28:31], s57 offen offset:3072 sc1
    s_waitcnt vmcnt(0)
    s_mov_b32 s60, 0
L_cn:
    v_xor_b32_e64 v26, s47, v64
    v_bitop3_b32 v26, v65, s47, v26 bitop3:0xbe
    v_bitop3_b32 v26, v66, s47, v26 bitop3:0xbe
    v_bitop3_b32 v26, v67, s47, v26 bitop3:0xbe
    v_cmp_lt_u32 vcc, 15, v26
    s_nop 0
    s_and_b64 vcc, vcc, -1
    s_cbranch_scc0 L_cn_ok
    s_sleep 8
    buffer_load_dword v64, v1, s[28:31], s57 offen offset:0 sc1
    buffer_load_dword v65, v1, s[28:31], s57 offen offset:1024 sc1
    buffer_load_dword v66, v1, s[28:31], s57 offen offset:2048 sc1
    buffer_load_dword v67, v1, s[28:31], s57 offen offset:3072 sc1
    s_add_u32 s60, s60, 1
    s_cmp_lt_u32 s60, 32768
    s_waitcnt vmcnt(0)
    s_cbranch_scc1 L_cn
L_cn_ok:
    v_mov_b32 v26, s47
    s_mov_b32 s56, 14417920
    s_mov_b64 exec, 1
    buffer_store_dword v26, v3, s[28:31], s56 offen sc1
    s_mov_b64 exec, -1
L_noep:
L_end:
    s_endpgm
L_G:
    s_setprio 2
    v_lshrrev_b32 v121, 5, v120
    s_mov_b32 s4, s64
    s_and_b32 s5, s65, 0xffff
    s_mov_b32 s6, 2097152
    s_mov_b32 s7, 0x20000
    s_mov_b32 s32, s92
    s_and_b32 s33, s93, 0xffff
    s_mov_b32 s34, 2097152
    s_mov_b32 s35, 0x20000
    s_lshl_b32 s57, s41, 1
    s_add_u32 s56, s53, s57
    s_mul_i32 s61, s56, 44
    s_add_u32 s61, s61, s45
    s_lshl_b32 s61, s61, 12
    s_lshl_b32 s57, s52, 11
    s_add_u32 s61, s61, s57
    s_add_u32 s61, s61, 8388608
    s_lshl_b32 s56, s56, 9
    s_lshl_b32 s57, s42, 5
    s_add_u32 s56, s56, s57
    s_lshl_b32 s57, s52, 4
    s_add_u32 s56, s56, s57
    s_add_u32 s62, s56, 14516224
    s_lshl_b32 s88, s43, 9
    s_add_u32 s88, s88, 14516224
    s_mul_i32 s56, s43, 44
    s_mul_i32 s57, s40, 11
    s_add_u32 s56, s56, s57
    s_lshl_b32 s56, s56, 12
    s_add_u32 s56, s56, 8388608
    s_add_u32 s36, s28, s56
    s_addc_u32 s37, s29, 0
    s_and_b32 s37, s37, 0xffff
    s_mov_b32 s38, 45056
    s_mov_b32 s39, 0x20000
    s_mul_i32 s56, s40, 360448
    s_lshl_b32 s57, s44, 7
    s_add_u32 s57, s56, s57
    s_add_u32 s24, s82, s57
    s_addc_u32 s25, s83, 0
    s_nop 0
    s_and_b32 s25, s25, 0xffff
    s_sub_u32 s26, 1409024, s57
    s_mov_b32 s27, 0x20000
    s_add_u32 s8, s62, 16384
    s_add_u32 s9, s88, 16384
    s_lshl_b32 s94, s40, 13
    s_lshl_b32 s58, s43, 1
    s_add_u32 s58, s58, s53
    s_lshl_b32 s89, s58, 8
    s_add_u32 s89, s89, 14483456
    s_lshl_b32 s22, s41, 10
    s_lshl_b32 s57, s40, 8
    s_add_u32 s22, s22, s57
    s_add_u32 s22, s22, 14483456
    s_lshl_b32 s57, s53, 15
    s_add_u32 s90, s63, s57
    s_lshl_b32 s57, s52, 6
    s_add_u32 s90, s90, s57
    s_lshl_b32 s91, s44, 18
    s_lshl_b32 s57, s52, 17
    s_add_u32 s91, s91, s57
    s_lshl_b32 s57, s58, 7
    s_add_u32 s91, s91, s57
    s_lshl_b32 s56, s44, 11
    s_lshl_b32 s57, s40, 9
    s_add_u32 s54, s56, s57
    s_lshl_b32 s57, s43, 4
    s_add_u32 s54, s54, s57
    s_add_u32 s54, s54, 14450688
    s_lshr_b32 s57, s58, 4
    s_lshl_b32 s57, s57, 9
    s_add_u32 s56, s56, s57
    s_lshl_b32 s57, s52, 8
    s_add_u32 s56, s56, s57
    s_add_u32 s55, s56, 14467072
    s_lshl_b32 s3, s44, 18
    s_lshl_b32 s57, s40, 16
    s_add_u32 s3, s3, s57
    s_lshl_b32 s57, s43, 7
    s_add_u32 s3, s3, s57
    v_lshlrev_b32 v12, 13, v122
    v_lshl_add_u32 v12, v123, 4, v12
    v_bfe_u32 v125, v120, 2, 2
    v_and_b32 v127, 3, v120
    v_lshlrev_b32 v127, 3, v127
    v_and_b32_e64 v126, 1, v124
    v_lshl_add_u32 v127, v126, 5, v127
    v_lshl_add_u32 v10, v121, 3, v125
    v_mul_u32_u24 v10, 192, v10
    v_add_u32_e64 v10, v10, v127
    v_add_u32 v10, 65536, v10
    v_lshl_add_u32 v14, v121, 2, v125
    v_lshl_add_u32 v14, v14, 7, v127
    v_and_b32 v125, 2, v125
    v_lshlrev_b32 v125, 5, v125
    v_xor_b32 v14, v14, v125
    s_lshl_b32 s56, s52, 6
    v_xor_b32 v14, s56, v14
    s_add_u32 s56, s94, 65536
    v_add_u32 v16, s56, v14
    v_add_u32 v14, s50, v14
    v_xor_b32 v15, 64, v14
    v_xor_b32 v17, 64, v16
    v_lshlrev_b32 v126, 2, v126
    v_xor_b32 v126, v126, v123
    v_lshlrev_b32 v126, 4, v126
    v_lshl_add_u32 v143, v122, 10, v126
    v_and_b32 v125, 31, v120
    v_lshlrev_b32 v2, 2, v125
    v_bfe_u32 v126, v125, 1, 3
    v_xor_b32 v126, v126, v121
    v_lshlrev_b32 v126, 4, v126
    v_lshl_add_u32 v126, v125, 7, v126
    v_add_u32 v6, s50, v126
    v_xor_b32 v7, 32, v6
    v_xor_b32 v8, 64, v6
    v_xor_b32 v9, 96, v6
    v_xor_b32 v126, v124, v120
    v_and_b32 v126, 1, v126
    v_lshlrev_b32 v126, 10, v126
    v_lshl_add_u32 v126, v121, 4, v126
    v_add_u32 v142, 161280, v126
    s_lshl_b32 s56, s40, 5
    s_add_u32 s56, s56, 97008
    v_mul_u32_u24 v11, 1040, v123
    v_lshl_add_u32 v11, v122, 2, v11
    v_add_u32 v11, s56, v11
    v_mov_b32 v22, 0xc0135761
    v_mov_b32 v23, 0xc0135761
    s_mov_b32 s20, 0xbdd2d3e8
    s_mov_b32 s21, 0xbdd2d3e8
    s_cmp_gt_u32 s46, 8
    s_cselect_b64 vcc, -1, 0
    v_cndmask_b32 v13, v128, v1, vcc
    s_nop 0
    v_accvgpr_write_b32 a1, 0
    v_accvgpr_write_b32 a2, 0
    v_accvgpr_write_b32 a3, 0
    v_accvgpr_write_b32 a5, 0
    v_accvgpr_write_b32 a6, 0
    v_accvgpr_write_b32 a7, 0
    v_accvgpr_write_b32 a9, 0
    v_accvgpr_write_b32 a10, 0
    v_accvgpr_write_b32 a11, 0
    v_accvgpr_write_b32 a13, 0
    v_accvgpr_write_b32 a14, 0
    v_accvgpr_write_b32 a15, 0
    v_accvgpr_write_b32 a17, 0
    v_accvgpr_write_b32 a18, 0
    v_accvgpr_write_b32 a19, 0
    v_cmp_eq_u32 vcc, 0, v121
    v_mov_b32 v125, 0x3f80
    s_nop 0
    v_cndmask_b32 v125, 0, v125, vcc
    v_accvgpr_write_b32 a16, v125
    s_lshl_b32 s56, s40, 7
    s_add_u32 s56, s56, 157696
    v_lshl_add_u32 v132, v122, 4, s56
    v_lshrrev_b32 v133, 1, v2
    v_add_u32 v133, 158208, v133
    s_lshl_b32 s56, s52, 6
    v_add_u32 v125, s56, v133
    v_mov_b32 v4, 158720
    s_waitcnt vmcnt(0)
    s_barrier
    s_nop 0
    ds_read_b128 v[136:139], v132
    ds_read_b32 v4, v4
    ds_read_u16 a0, v133 offset:0
    ds_read_u16 a4, v133 offset:64
    ds_read_u16 a8, v133 offset:128
    ds_read_u16 a12, v125 offset:256
    ds_read_b32 v72, v11 offset:640
    ds_read_b32 v73, v11 offset:768
    ds_read_b32 v74, v11 offset:896
    ds_read_b32 v75, v11 offset:1040
    ds_read_b32 v76, v11 offset:1168
    ds_read_b32 v77, v11 offset:1296
    ds_read_b32 v78, v11 offset:1424
    ds_read_b32 v79, v11 offset:1552
    ds_read_b32 v80, v11 offset:1680
    ds_read_b32 v81, v11 offset:1808
    ds_read_b32 v82, v11 offset:1936
    ds_read_b32 v83, v11 offset:9360
    ds_read_b32 v84, v11 offset:9488
    ds_read_b32 v85, v11 offset:9616
    ds_read_b32 v86, v11 offset:9744
    ds_read_b32 v87, v11 offset:9872
    ds_read_b32 v88, v11 offset:10000
    ds_read_b32 v89, v11 offset:10128
    ds_read_b32 v90, v11 offset:10256
    s_waitcnt lgkmcnt(0)
    s_barrier
    v_lshlrev_b32 v96, 16, v136
    v_and_b32 v98, s96, v136
    v_lshlrev_b32 v100, 16, v137
    v_and_b32 v102, s96, v137
    v_lshlrev_b32 v97, 16, v138
    v_and_b32 v99, s96, v138
    v_lshlrev_b32 v101, 16, v139
    v_and_b32 v103, s96, v139
    v_add_u32 v4, 2654435760, v4
    v_and_b32 v4, 0xfffffff0, v4
    s_nop 0
    v_readfirstlane_b32 s47, v4
    v_lshlrev_b32 v104, 16, v72
    v_and_b32 v105, s96, v72
    v_lshlrev_b32 v106, 16, v73
    v_and_b32 v107, s96, v73
    v_lshlrev_b32 v108, 16, v74
    v_and_b32 v109, s96, v74
    v_lshlrev_b32 v110, 16, v75
    v_and_b32 v111, s96, v75
    v_lshlrev_b32 v112, 16, v76
    v_and_b32 v113, s96, v76
    v_lshlrev_b32 v114, 16, v77
    v_and_b32 v115, s96, v77
    v_lshlrev_b32 v116, 16, v78
    v_and_b32 v117, s96, v78
    v_lshlrev_b32 v118, 16, v79
    v_and_b32 v119, s96, v79
    v_lshlrev_b32 v120, 16, v80
    v_and_b32 v121, s96, v80
    v_lshlrev_b32 v122, 16, v81
    v_and_b32 v123, s96, v81
    v_lshlrev_b32 v124, 16, v82
    v_and_b32_e64 v125, s96, v82
    v_pk_mul_f32 v[126:127], v[110:111], v[96:97]
    v_pk_mul_f32 v[128:129], v[112:113], v[96:97]
    v_pk_mul_f32 v[130:131], v[114:115], v[96:97]
    v_pk_mul_f32 v[132:133], v[116:117], v[96:97]
    v_pk_mul_f32 v[134:135], v[118:119], v[96:97]
    v_pk_mul_f32 v[136:137], v[120:121], v[96:97]
    v_pk_mul_f32 v[138:139], v[122:123], v[96:97]
    v_pk_mul_f32 v[140:141], v[124:125], v[96:97]
    v_pk_fma_f32 v[126:127], v[108:109], v[98:99], v[126:127]
    v_pk_fma_f32 v[128:129], v[110:111], v[98:99], v[128:129]
    v_pk_fma_f32 v[130:131], v[112:113], v[98:99], v[130:131]
    v_pk_fma_f32 v[132:133], v[114:115], v[98:99], v[132:133]
    v_pk_fma_f32 v[134:135], v[116:117], v[98:99], v[134:135]
    v_pk_fma_f32 v[136:137], v[118:119], v[98:99], v[136:137]
    v_pk_fma_f32 v[138:139], v[120:121], v[98:99], v[138:139]
    v_pk_fma_f32 v[140:141], v[122:123], v[98:99], v[140:141]
    v_pk_fma_f32 v[126:127], v[106:107], v[100:101], v[126:127]
    v_pk_fma_f32 v[128:129], v[108:109], v[100:101], v[128:129]
    v_pk_fma_f32 v[130:131], v[110:111], v[100:101], v[130:131]
    v_pk_fma_f32 v[132:133], v[112:113], v[100:101], v[132:133]
    v_pk_fma_f32 v[134:135], v[114:115], v[100:101], v[134:135]
    v_pk_fma_f32 v[136:137], v[116:117], v[100:101], v[136:137]
    v_pk_fma_f32 v[138:139], v[118:119], v[100:101], v[138:139]
    v_pk_fma_f32 v[140:141], v[120:121], v[100:101], v[140:141]
    v_pk_fma_f32 v[126:127], v[104:105], v[102:103], v[126:127]
    v_pk_fma_f32 v[128:129], v[106:107], v[102:103], v[128:129]
    v_pk_fma_f32 v[130:131], v[108:109], v[102:103], v[130:131]
    v_pk_fma_f32 v[132:133], v[110:111], v[102:103], v[132:133]
    v_pk_fma_f32 v[134:135], v[112:113], v[102:103], v[134:135]
    v_pk_fma_f32 v[136:137], v[114:115], v[102:103], v[136:137]
    v_pk_fma_f32 v[138:139], v[116:117], v[102:103], v[138:139]
    v_pk_fma_f32 v[140:141], v[118:119], v[102:103], v[140:141]
    v_lshlrev_b32 v104, 16, v83
    v_and_b32 v105, s96, v83
    v_lshlrev_b32 v106, 16, v84
    v_and_b32 v107, s96, v84
    v_lshlrev_b32 v108, 16, v85
    v_and_b32 v109, s96, v85
    v_lshlrev_b32 v110, 16, v86
    v_and_b32 v111, s96, v86
    v_lshlrev_b32 v112, 16, v87
    v_and_b32 v113, s96, v87
    v_lshlrev_b32 v114, 16, v88
    v_and_b32 v115, s96, v88
    v_lshlrev_b32 v116, 16, v89
    v_and_b32 v117, s96, v89
    v_lshlrev_b32 v118, 16, v90
    v_and_b32 v119, s96, v90
    v_pk_mul_f32 v[126:127], v[126:127], v[104:105]
    v_pk_mul_f32 v[128:129], v[128:129], v[106:107]
    v_pk_mul_f32 v[130:131], v[130:131], v[108:109]
    v_pk_mul_f32 v[132:133], v[132:133], v[110:111]
    v_pk_mul_f32 v[134:135], v[134:135], v[112:113]
    v_pk_mul_f32 v[136:137], v[136:137], v[114:115]
    v_pk_mul_f32 v[138:139], v[138:139], v[116:117]
    v_pk_mul_f32 v[140:141], v[140:141], v[118:119]
    v_cvt_pk_bf16_f32 v104, v126, v128
    v_cvt_pk_bf16_f32 v105, v130, v132
    v_cvt_pk_bf16_f32 v106, v134, v136
    v_cvt_pk_bf16_f32 v107, v138, v140
    v_cvt_pk_bf16_f32 v108, v127, v129
    v_cvt_pk_bf16_f32 v109, v131, v133
    v_cvt_pk_bf16_f32 v110, v135, v137
    v_cvt_pk_bf16_f32 v111, v139, v141
    s_add_u32 s56, s3, 4096
    buffer_store_dwordx4 v[104:107], v12, s[28:31], s3 offen sc1
    buffer_store_dwordx4 v[108:111], v12, s[28:31], s56 offen sc1
    v_mfma_f32_32x32x16_bf16 v[24:39], a[0:3], a[16:19], 0
    v_mfma_f32_32x32x16_bf16 v[40:55], a[4:7], a[16:19], 0
    v_mfma_f32_32x32x16_bf16 v[56:71], a[8:11], a[16:19], 0
    v_mfma_f32_32x32x16_bf16 v[72:87], a[12:15], a[16:19], 0
    s_cmp_lg_u32 s40, 0
    s_cbranch_scc1 L_noarr
    s_lshl_b32 s56, s2, 4
    s_add_u32 s56, s56, 14422016
    s_mov_b64 exec, 1
    buffer_store_dword v4, v3, s[28:31], s56 offen sc1
    s_mov_b64 exec, -1
L_noarr:
    s_barrier
    s_cmp_eq_u32 s42, 15
    s_cbranch_scc1 L_gate
    ds_read_b128 a[64:67], v6 offset:0
    ds_read_b64_tr_b16 a[68:69], v10 offset:0
    ds_read_b64_tr_b16 a[70:71], v10 offset:768
    ds_read_b64_tr_b16 a[72:73], v10 offset:64
    ds_read_b64_tr_b16 a[74:75], v10 offset:832
    ds_read_b64_tr_b16 a[76:77], v10 offset:128
    ds_read_b64_tr_b16 a[78:79], v10 offset:896
    ds_read_b128 a[80:83], v7 offset:0
    ds_read_b64_tr_b16 a[84:85], v10 offset:3072
    ds_read_b64_tr_b16 a[86:87], v10 offset:3840
    ds_read_b64_tr_b16 a[88:89], v10 offset:3136
    ds_read_b64_tr_b16 a[90:91], v10 offset:3904
    ds_read_b64_tr_b16 a[92:93], v10 offset:3200
    ds_read_b64_tr_b16 a[94:95], v10 offset:3968
    s_waitcnt lgkmcnt(7)
    v_mfma_f32_32x32x16_bf16 v[24:39], a[68:71], a[64:67], v[24:39]
    ds_read_b128 a[96:99], v8 offset:0
    ds_read_b64_tr_b16 a[100:101], v10 offset:6144
    ds_read_b64_tr_b16 a[102:103], v10 offset:6912
    v_mfma_f32_32x32x16_bf16 v[40:55], a[72:75], a[64:67], v[40:55]
    ds_read_b64_tr_b16 a[104:105], v10 offset:6208
    ds_read_b64_tr_b16 a[106:107], v10 offset:6976
    v_mfma_f32_32x32x16_bf16 v[56:71], a[76:79], a[64:67], v[56:71]
    ds_read_b64_tr_b16 a[108:109], v10 offset:6272
    ds_read_b64_tr_b16 a[110:111], v10 offset:7040
    s_waitcnt lgkmcnt(7)
    v_mfma_f32_32x32x16_bf16 v[24:39], a[84:87], a[80:83], v[24:39]
    ds_read_b128 a[64:67], v9 offset:0
    ds_read_b64_tr_b16 a[68:69], v10 offset:9216
    ds_read_b64_tr_b16 a[70:71], v10 offset:9984
    v_mfma_f32_32x32x16_bf16 v[40:55], a[88:91], a[80:83], v[40:55]
    ds_read_b64_tr_b16 a[72:73], v10 offset:9280
    ds_read_b64_tr_b16 a[74:75], v10 offset:10048
    v_mfma_f32_32x32x16_bf16 v[56:71], a[92:95], a[80:83], v[56:71]
    ds_read_b64_tr_b16 a[76:77], v10 offset:9344
    ds_read_b64_tr_b16 a[78:79], v10 offset:10112
    s_waitcnt lgkmcnt(0)
    s_barrier
    v_mfma_f32_32x32x16_bf16 v[24:39], a[100:103], a[96:99], v[24:39]
    ds_read_b128 a[80:83], v6 offset:4096
    ds_read_b64_tr_b16 a[84:85], v10 offset:12288
    ds_read_b64_tr_b16 a[86:87], v10 offset:13056
    v_mfma_f32_32x32x16_bf16 v[40:55], a[104:107], a[96:99], v[40:55]
    ds_read_b64_tr_b16 a[88:89], v10 offset:12352
    ds_read_b64_tr_b16 a[90:91], v10 offset:13120
    v_mfma_f32_32x32x16_bf16 v[56:71], a[108:111], a[96:99], v[56:71]
    ds_read_b64_tr_b16 a[92:93], v10 offset:12416
    ds_read_b64_tr_b16 a[94:95], v10 offset:13184
    v_mfma_f32_32x32x16_bf16 v[24:39], a[68:71], a[64:67], v[24:39]
    ds_read_b128 a[96:99], v7 offset:4096
    ds_read_b64_tr_b16 a[100:101], v10 offset:15360
    ds_read_b64_tr_b16 a[102:103], v10 offset:16128
    v_mfma_f32_32x32x16_bf16 v[40:55], a[72:75], a[64:67], v[40:55]
    ds_read_b64_tr_b16 a[104:105], v10 offset:15424
    ds_read_b64_tr_b16 a[106:107], v10 offset:16192
    v_mfma_f32_32x32x16_bf16 v[56:71], a[76:79], a[64:67], v[56:71]
    ds_read_b64_tr_b16 a[108:109], v10 offset:15488
    ds_read_b64_tr_b16 a[110:111], v10 offset:16256
    s_waitcnt lgkmcnt(7)
    v_mfma_f32_32x32x16_bf16 v[24:39], a[84:87], a[80:83], v[24:39]
    ds_read_b128 a[64:67], v8 offset:4096
    ds_read_b64_tr_b16 a[68:69], v10 offset:18432
    ds_read_b64_tr_b16 a[70:71], v10 offset:19200
    v_lshrrev_b32 v110, 9, v1
    v_mfma_f32_32x32x16_bf16 v[40:55], a[88:91], a[80:83], v[40:55]
    ds_read_b64_tr_b16 a[72:73], v10 offset:18496
    ds_read_b64_tr_b16 a[74:75], v10 offset:19264
    s_lshl_b32 s56, s40, 11
    v_mfma_f32_32x32x16_bf16 v[56:71], a[92:95], a[80:83], v[56:71]
    ds_read_b64_tr_b16 a[76:77], v10 offset:18560
    ds_read_b64_tr_b16 a[78:79], v10 offset:19328
    s_add_u32 s58, s56, 102400
    s_waitcnt lgkmcnt(7)
    v_mfma_f32_32x32x16_bf16 v[24:39], a[100:103], a[96:99], v[24:39]
    ds_read_b128 a[80:83], v9 offset:4096
    ds_read_b64_tr_b16 a[84:85], v10 offset:21504
    ds_read_b64_tr_b16 a[86:87], v10 offset:22272
    v_lshl_add_u32 v18, v2, 4, s58
    v_mfma_f32_32x32x16_bf16 v[40:55], a[104:107], a[96:99], v[40:55]
    ds_read_b64_tr_b16 a[88:89], v10 offset:21568
    ds_read_b64_tr_b16 a[90:91], v10 offset:22336
    v_lshl_add_u32 v18, v110, 3, v18
    v_mfma_f32_32x32x16_bf16 v[56:71], a[108:111], a[96:99], v[56:71]
    ds_read_b64_tr_b16 a[92:93], v10 offset:21632
    ds_read_b64_tr_b16 a[94:95], v10 offset:22400
    v_add_u32 v19, s58, v1
    s_waitcnt lgkmcnt(0)
    s_barrier
    v_mfma_f32_32x32x16_bf16 v[24:39], a[68:71], a[64:67], v[24:39]
    ds_read_b128 a[96:99], v6 offset:8192
    ds_read_b64_tr_b16 a[100:101], v10 offset:24576
    ds_read_b64_tr_b16 a[102:103], v10 offset:25344
    v_and_b32 v111, 24, v2
    v_mfma_f32_32x32x16_bf16 v[40:55], a[72:75], a[64:67], v[40:55]
    ds_read_b64_tr_b16 a[104:105], v10 offset:24640
    ds_read_b64_tr_b16 a[106:107], v10 offset:25408
    v_lshl_add_u32 v18, v111, 1, v18
    v_mfma_f32_32x32x16_bf16 v[56:71], a[76:79], a[64:67], v[56:71]
    ds_read_b64_tr_b16 a[108:109], v10 offset:24704
    ds_read_b64_tr_b16 a[110:111], v10 offset:25472
    v_lshrrev_b32 v20, 6, v1
    v_mfma_f32_32x32x16_bf16 v[24:39], a[84:87], a[80:83], v[24:39]
    ds_read_b128 a[64:67], v7 offset:8192
    ds_read_b64_tr_b16 a[68:69], v10 offset:27648
    ds_read_b64_tr_b16 a[70:71], v10 offset:28416
    v_lshrrev_b32 v111, 3, v1
    v_mfma_f32_32x32x16_bf16 v[40:55], a[88:91], a[80:83], v[40:55]
    ds_read_b64_tr_b16 a[72:73], v10 offset:27712
    ds_read_b64_tr_b16 a[74:75], v10 offset:28480
    v_xor_b32 v111, v111, v1
    v_mfma_f32_32x32x16_bf16 v[56:71], a[92:95], a[80:83], v[56:71]
    ds_read_b64_tr_b16 a[76:77], v10 offset:27776
    ds_read_b64_tr_b16 a[78:79], v10 offset:28544
    v_and_b32 v111, 48, v111
    s_waitcnt lgkmcnt(7)
    s_nop 0
    v_mfma_f32_32x32x16_bf16 v[24:39], a[100:103], a[96:99], v[24:39]
    ds_read_b128 a[80:83], v8 offset:8192
    ds_read_b64_tr_b16 a[84:85], v10 offset:30720
    ds_read_b64_tr_b16 a[86:87], v10 offset:31488
    v_lshl_add_u32 v20, v20, 10, v111
    v_mfma_f32_32x32x16_bf16 v[40:55], a[104:107], a[96:99], v[40:55]
    ds_read_b64_tr_b16 a[88:89], v10 offset:30784
    ds_read_b64_tr_b16 a[90:91], v10 offset:31552
    v_lshl_add_u32 v21, v110, 14, v2
    s_waitcnt vmcnt(0)
    s_mov_b64 exec, 1
    buffer_store_dword v4, v3, s[28:31], s54 offen sc1
    s_mov_b64 exec, -1
    v_mfma_f32_32x32x16_bf16 v[56:71], a[108:111], a[96:99], v[56:71]
    ds_read_b64_tr_b16 a[92:93], v10 offset:30848
    ds_read_b64_tr_b16 a[94:95], v10 offset:31616
    v_lshlrev_b32 v11, 1, v2
    s_waitcnt lgkmcnt(7)
    v_mfma_f32_32x32x16_bf16 v[24:39], a[68:71], a[64:67], v[24:39]
    ds_read_b128 a[96:99], v9 offset:8192
    ds_read_b64_tr_b16 a[100:101], v10 offset:33792
    ds_read_b64_tr_b16 a[102:103], v10 offset:34560
    v_and_b32 v12, 0x70, v1
    v_mfma_f32_32x32x16_bf16 v[40:55], a[72:75], a[64:67], v[40:55]
    ds_read_b64_tr_b16 a[104:105], v10 offset:33856
    ds_read_b64_tr_b16 a[106:107], v10 offset:34624
    s_lshl_b32 s56, s40, 7
    v_mfma_f32_32x32x16_bf16 v[56:71], a[76:79], a[64:67], v[56:71]
    ds_read_b64_tr_b16 a[108:109], v10 offset:33920
    ds_read_b64_tr_b16 a[110:111], v10 offset:34688
    v_add_u32 v12, s56, v12
    s_waitcnt lgkmcnt(0)
    s_barrier
    v_mfma_f32_32x32x16_bf16 v[24:39], a[84:87], a[80:83], v[24:39]
    ds_read_b128 a[64:67], v6 offset:12288
    ds_read_b64_tr_b16 a[68:69], v10 offset:36864
    ds_read_b64_tr_b16 a[70:71], v10 offset:37632
    v_or_b32 v111, 0x1e0, v12
    v_mfma_f32_32x32x16_bf16 v[40:55], a[88:91], a[80:83], v[40:55]
    ds_read_b64_tr_b16 a[72:73], v10 offset:36928
    ds_read_b64_tr_b16 a[74:75], v10 offset:37696
    v_cmp_gt_u32 vcc, 512, v1
    v_mfma_f32_32x32x16_bf16 v[56:71], a[92:95], a[80:83], v[56:71]
    ds_read_b64_tr_b16 a[76:77], v10 offset:36992
    ds_read_b64_tr_b16 a[78:79], v10 offset:37760
    v_cndmask_b32 v12, v111, v12, vcc
    v_mfma_f32_32x32x16_bf16 v[24:39], a[100:103], a[96:99], v[24:39]
    ds_read_b128 a[80:83], v7 offset:12288
    ds_read_b64_tr_b16 a[84:85], v10 offset:39936
    ds_read_b64_tr_b16 a[86:87], v10 offset:40704
    v_lshlrev_b32 v12, 0, v12
    v_mfma_f32_32x32x16_bf16 v[40:55], a[104:107], a[96:99], v[40:55]
    ds_read_b64_tr_b16 a[88:89], v10 offset:40000
    ds_read_b64_tr_b16 a[90:91], v10 offset:40768
    s_add_u32 s12, s91, 0
    v_mfma_f32_32x32x16_bf16 v[56:71], a[108:111], a[96:99], v[56:71]
    ds_read_b64_tr_b16 a[92:93], v10 offset:40064
    ds_read_b64_tr_b16 a[94:95], v10 offset:40832
    s_add_u32 s13, s91, 8192
    s_waitcnt lgkmcnt(7)
    s_nop 0
    v_mfma_f32_32x32x16_bf16 v[24:39], a[68:71], a[64:67], v[24:39]
    ds_read_b128 a[96:99], v8 offset:12288
    ds_read_b64_tr_b16 a[100:101], v10 offset:43008
    ds_read_b64_tr_b16 a[102:103], v10 offset:43776
    s_add_u32 s14, s91, 32768
    v_mfma_f32_32x32x16_bf16 v[40:55], a[72:75], a[64:67], v[40:55]
    ds_read_b64_tr_b16 a[104:105], v10 offset:43072
    ds_read_b64_tr_b16 a[106:107], v10 offset:43840
    s_add_u32 s15, s91, 40960
    v_mfma_f32_32x32x16_bf16 v[56:71], a[76:79], a[64:67], v[56:71]
    ds_read_b64_tr_b16 a[108:109], v10 offset:43136
    ds_read_b64_tr_b16 a[110:111], v10 offset:43904
    s_add_u32 s16, s91, 65536
    s_waitcnt lgkmcnt(7)
    s_nop 0
    v_mfma_f32_32x32x16_bf16 v[24:39], a[84:87], a[80:83], v[24:39]
    ds_read_b128 a[64:67], v9 offset:12288
    ds_read_b64_tr_b16 a[68:69], v10 offset:46080
    ds_read_b64_tr_b16 a[70:71], v10 offset:46848
    s_add_u32 s17, s91, 73728
    v_mfma_f32_32x32x16_bf16 v[40:55], a[88:91], a[80:83], v[40:55]
    ds_read_b64_tr_b16 a[72:73], v10 offset:46144
    ds_read_b64_tr_b16 a[74:75], v10 offset:46912
    s_add_u32 s18, s91, 98304
    v_mfma_f32_32x32x16_bf16 v[56:71], a[92:95], a[80:83], v[56:71]
    ds_read_b64_tr_b16 a[76:77], v10 offset:46208
    ds_read_b64_tr_b16 a[78:79], v10 offset:46976
    s_add_u32 s19, s91, 106496
    s_waitcnt lgkmcnt(0)
    s_barrier
    v_mfma_f32_32x32x16_bf16 v[24:39], a[100:103], a[96:99], v[24:39]
    ds_read_b128 a[80:83], v6 offset:0
    ds_read_b64_tr_b16 a[84:85], v10 offset:0
    ds_read_b64_tr_b16 a[86:87], v10 offset:768
    s_add_u32 s59, s90, 15360
    v_mfma_f32_32x32x16_bf16 v[40:55], a[104:107], a[96:99], v[40:55]
    ds_read_b64_tr_b16 a[88:89], v10 offset:64
    ds_read_b64_tr_b16 a[90:91], v10 offset:832
    v_mfma_f32_32x32x16_bf16 v[56:71], a[108:111], a[96:99], v[56:71]
    ds_read_b64_tr_b16 a[92:93], v10 offset:128
    ds_read_b64_tr_b16 a[94:95], v10 offset:896
    v_mfma_f32_32x32x16_bf16 v[24:39], a[68:71], a[64:67], v[24:39]
    ds_read_b128 a[96:99], v7 offset:0
    ds_read_b64_tr_b16 a[100:101], v10 offset:3072
    ds_read_b64_tr_b16 a[102:103], v10 offset:3840
    v_mfma_f32_32x32x16_bf16 v[40:55], a[72:75], a[64:67], v[40:55]
    ds_read_b64_tr_b16 a[104:105], v10 offset:3136
    ds_read_b64_tr_b16 a[106:107], v10 offset:3904
    v_mfma_f32_32x32x16_bf16 v[56:71], a[76:79], a[64:67], v[56:71]
    ds_read_b64_tr_b16 a[108:109], v10 offset:3200
    ds_read_b64_tr_b16 a[110:111], v10 offset:3968
    s_waitcnt lgkmcnt(7)
    v_mfma_f32_32x32x16_bf16 v[24:39], a[84:87], a[80:83], v[24:39]
    ds_read_b128 a[64:67], v8 offset:0
    ds_read_b64_tr_b16 a[68:69], v10 offset:6144
    ds_read_b64_tr_b16 a[70:71], v10 offset:6912
    v_mfma_f32_32x32x16_bf16 v[40:55], a[88:91], a[80:83], v[40:55]
    ds_read_b64_tr_b16 a[72:73], v10 offset:6208
    ds_read_b64_tr_b16 a[74:75], v10 offset:6976
    v_mfma_f32_32x32x16_bf16 v[56:71], a[92:95], a[80:83], v[56:71]
    ds_read_b64_tr_b16 a[76:77], v10 offset:6272
    ds_read_b64_tr_b16 a[78:79], v10 offset:7040
    s_waitcnt lgkmcnt(7)
    v_mfma_f32_32x32x16_bf16 v[24:39], a[100:103], a[96:99], v[24:39]
    ds_read_b128 a[80:83], v9 offset:0
    ds_read_b64_tr_b16 a[84:85], v10 offset:9216
    ds_read_b64_tr_b16 a[86:87], v10 offset:9984
    v_mfma_f32_32x32x16_bf16 v[40:55], a[104:107], a[96:99], v[40:55]
    ds_read_b64_tr_b16 a[88:89], v10 offset:9280
    ds_read_b64_tr_b16 a[90:91], v10 offset:10048
    v_mfma_f32_32x32x16_bf16 v[56:71], a[108:111], a[96:99], v[56:71]
    ds_read_b64_tr_b16 a[92:93], v10 offset:9344
    ds_read_b64_tr_b16 a[94:95], v10 offset:10112
    s_waitcnt lgkmcnt(0)
    s_barrier
    v_mfma_f32_32x32x16_bf16 v[24:39], a[68:71], a[64:67], v[24:39]
    ds_read_b128 a[96:99], v6 offset:4096
    ds_read_b64_tr_b16 a[100:101], v10 offset:12288
    ds_read_b64_tr_b16 a[102:103], v10 offset:13056
    v_mfma_f32_32x32x16_bf16 v[40:55], a[72:75], a[64:67], v[40:55]
    ds_read_b64_tr_b16 a[104:105], v10 offset:12352
    ds_read_b64_tr_b16 a[106:107], v10 offset:13120
    v_mfma_f32_32x32x16_bf16 v[56:71], a[76:79], a[64:67], v[56:71]
    ds_read_b64_tr_b16 a[108:109], v10 offset:12416
    ds_read_b64_tr_b16 a[110:111], v10 offset:13184
    v_mfma_f32_32x32x16_bf16 v[24:39], a[84:87], a[80:83], v[24:39]
    ds_read_b128 a[64:67], v7 offset:4096
    ds_read_b64_tr_b16 a[68:69], v10 offset:15360
    ds_read_b64_tr_b16 a[70:71], v10 offset:16128
    v_mfma_f32_32x32x16_bf16 v[40:55], a[88:91], a[80:83], v[40:55]
    ds_read_b64_tr_b16 a[72:73], v10 offset:15424
    ds_read_b64_tr_b16 a[74:75], v10 offset:16192
    v_mfma_f32_32x32x16_bf16 v[56:71], a[92:95], a[80:83], v[56:71]
    ds_read_b64_tr_b16 a[76:77], v10 offset:15488
    ds_read_b64_tr_b16 a[78:79], v10 offset:16256
    s_waitcnt lgkmcnt(7)
    v_mfma_f32_32x32x16_bf16 v[24:39], a[100:103], a[96:99], v[24:39]
    ds_read_b128 a[80:83], v8 offset:4096
    ds_read_b64_tr_b16 a[84:85], v10 offset:18432
    ds_read_b64_tr_b16 a[86:87], v10 offset:19200
    v_mfma_f32_32x32x16_bf16 v[40:55], a[104:107], a[96:99], v[40:55]
    ds_read_b64_tr_b16 a[88:89], v10 offset:18496
    ds_read_b64_tr_b16 a[90:91], v10 offset:19264
    v_mfma_f32_32x32x16_bf16 v[56:71], a[108:111], a[96:99], v[56:71]
    ds_read_b64_tr_b16 a[92:93], v10 offset:18560
    ds_read_b64_tr_b16 a[94:95], v10 offset:19328
    s_waitcnt lgkmcnt(7)
    v_mfma_f32_32x32x16_bf16 v[24:39], a[68:71], a[64:67], v[24:39]
    ds_read_b128 a[96:99], v9 offset:4096
    ds_read_b64_tr_b16 a[100:101], v10 offset:21504
    ds_read_b64_tr_b16 a[102:103], v10 offset:22272
    v_mfma_f32_32x32x16_bf16 v[40:55], a[72:75], a[64:67], v[40:55]
    ds_read_b64_tr_b16 a[104:105], v10 offset:21568
    ds_read_b64_tr_b16 a[106:107], v10 offset:22336
    v_mfma_f32_32x32x16_bf16 v[56:71], a[76:79], a[64:67], v[56:71]
    ds_read_b64_tr_b16 a[108:109], v10 offset:21632
    ds_read_b64_tr_b16 a[110:111], v10 offset:22400
    s_waitcnt lgkmcnt(0)
    s_barrier
    v_mfma_f32_32x32x16_bf16 v[24:39], a[84:87], a[80:83], v[24:39]
    ds_read_b128 a[64:67], v6 offset:8192
    ds_read_b64_tr_b16 a[68:69], v10 offset:24576
    ds_read_b64_tr_b16 a[70:71], v10 offset:25344
    v_mfma_f32_32x32x16_bf16 v[40:55], a[88:91], a[80:83], v[40:55]
    ds_read_b64_tr_b16 a[72:73], v10 offset:24640
    ds_read_b64_tr_b16 a[74:75], v10 offset:25408
    v_mfma_f32_32x32x16_bf16 v[56:71], a[92:95], a[80:83], v[56:71]
    ds_read_b64_tr_b16 a[76:77], v10 offset:24704
    ds_read_b64_tr_b16 a[78:79], v10 offset:25472
    v_mfma_f32_32x32x16_bf16 v[24:39], a[100:103], a[96:99], v[24:39]
    ds_read_b128 a[80:83], v7 offset:8192
    ds_read_b64_tr_b16 a[84:85], v10 offset:27648
    ds_read_b64_tr_b16 a[86:87], v10 offset:28416
    v_mfma_f32_32x32x16_bf16 v[40:55], a[104:107], a[96:99], v[40:55]
    ds_read_b64_tr_b16 a[88:89], v10 offset:27712
    ds_read_b64_tr_b16 a[90:91], v10 offset:28480
    v_mfma_f32_32x32x16_bf16 v[56:71], a[108:111], a[96:99], v[56:71]
    ds_read_b64_tr_b16 a[92:93], v10 offset:27776
    ds_read_b64_tr_b16 a[94:95], v10 offset:28544
    s_waitcnt lgkmcnt(7)
    v_mfma_f32_32x32x16_bf16 v[24:39], a[68:71], a[64:67], v[24:39]
    ds_read_b128 a[96:99], v8 offset:8192
    ds_read_b64_tr_b16 a[100:101], v10 offset:30720
    ds_read_b64_tr_b16 a[102:103], v10 offset:31488
    v_mfma_f32_32x32x16_bf16 v[40:55], a[72:75], a[64:67], v[40:55]
    ds_read_b64_tr_b16 a[104:105], v10 offset:30784
    ds_read_b64_tr_b16 a[106:107], v10 offset:31552
    v_mfma_f32_32x32x16_bf16 v[56:71], a[76:79], a[64:67], v[56:71]
    ds_read_b64_tr_b16 a[108:109], v10 offset:30848
    ds_read_b64_tr_b16 a[110:111], v10 offset:31616
    s_waitcnt lgkmcnt(7)
    v_mfma_f32_32x32x16_bf16 v[24:39], a[84:87], a[80:83], v[24:39]
    ds_read_b128 a[64:67], v9 offset:8192
    ds_read_b64_tr_b16 a[68:69], v10 offset:33792
    ds_read_b64_tr_b16 a[70:71], v10 offset:34560
    v_mfma_f32_32x32x16_bf16 v[40:55], a[88:91], a[80:83], v[40:55]
    ds_read_b64_tr_b16 a[72:73], v10 offset:33856
    ds_read_b64_tr_b16 a[74:75], v10 offset:34624
    v_mfma_f32_32x32x16_bf16 v[56:71], a[92:95], a[80:83], v[56:71]
    ds_read_b64_tr_b16 a[76:77], v10 offset:33920
    ds_read_b64_tr_b16 a[78:79], v10 offset:34688
    s_waitcnt lgkmcnt(0)
    s_barrier
    v_mfma_f32_32x32x16_bf16 v[24:39], a[100:103], a[96:99], v[24:39]
    ds_read_b128 a[80:83], v6 offset:12288
    ds_read_b64_tr_b16 a[84:85], v10 offset:36864
    ds_read_b64_tr_b16 a[86:87], v10 offset:37632
    v_mfma_f32_32x32x16_bf16 v[40:55], a[104:107], a[96:99], v[40:55]
    ds_read_b64_tr_b16 a[88:89], v10 offset:36928
    ds_read_b64_tr_b16 a[90:91], v10 offset:37696
    v_mfma_f32_32x32x16_bf16 v[56:71], a[108:111], a[96:99], v[56:71]
    ds_read_b64_tr_b16 a[92:93], v10 offset:36992
    ds_read_b64_tr_b16 a[94:95], v10 offset:37760
    v_mfma_f32_32x32x16_bf16 v[24:39], a[68:71], a[64:67], v[24:39]
    ds_read_b128 a[96:99], v7 offset:12288
    ds_read_b64_tr_b16 a[100:101], v10 offset:39936
    ds_read_b64_tr_b16 a[102:103], v10 offset:40704
    v_mfma_f32_32x32x16_bf16 v[40:55], a[72:75], a[64:67], v[40:55]
    ds_read_b64_tr_b16 a[104:105], v10 offset:40000
    ds_read_b64_tr_b16 a[106:107], v10 offset:40768
    v_mfma_f32_32x32x16_bf16 v[56:71], a[76:79], a[64:67], v[56:71]
    ds_read_b64_tr_b16 a[108:109], v10 offset:40064
    ds_read_b64_tr_b16 a[110:111], v10 offset:40832
    s_waitcnt lgkmcnt(7)
    v_mfma_f32_32x32x16_bf16 v[24:39], a[84:87], a[80:83], v[24:39]
    ds_read_b128 a[64:67], v8 offset:12288
    ds_read_b64_tr_b16 a[68:69], v10 offset:43008
    ds_read_b64_tr_b16 a[70:71], v10 offset:43776
    v_mfma_f32_32x32x16_bf16 v[40:55], a[88:91], a[80:83], v[40:55]
    ds_read_b64_tr_b16 a[72:73], v10 offset:43072
    ds_read_b64_tr_b16 a[74:75], v10 offset:43840
    v_mfma_f32_32x32x16_bf16 v[56:71], a[92:95], a[80:83], v[56:71]
    ds_read_b64_tr_b16 a[76:77], v10 offset:43136
    ds_read_b64_tr_b16 a[78:79], v10 offset:43904
    s_waitcnt lgkmcnt(7)
    v_mfma_f32_32x32x16_bf16 v[24:39], a[100:103], a[96:99], v[24:39]
    ds_read_b128 a[80:83], v9 offset:12288
    ds_read_b64_tr_b16 a[84:85], v10 offset:46080
    ds_read_b64_tr_b16 a[86:87], v10 offset:46848
    v_mfma_f32_32x32x16_bf16 v[40:55], a[104:107], a[96:99], v[40:55]
    ds_read_b64_tr_b16 a[88:89], v10 offset:46144
    ds_read_b64_tr_b16 a[90:91], v10 offset:46912
    v_mfma_f32_32x32x16_bf16 v[56:71], a[108:111], a[96:99], v[56:71]
    ds_read_b64_tr_b16 a[92:93], v10 offset:46208
    ds_read_b64_tr_b16 a[94:95], v10 offset:46976
    s_waitcnt lgkmcnt(0)
    s_barrier
    v_mfma_f32_32x32x16_bf16 v[24:39], a[68:71], a[64:67], v[24:39]
    v_mfma_f32_32x32x16_bf16 v[40:55], a[72:75], a[64:67], v[40:55]
    v_mfma_f32_32x32x16_bf16 v[56:71], a[76:79], a[64:67], v[56:71]
    v_mfma_f32_32x32x16_bf16 v[24:39], a[84:87], a[80:83], v[24:39]
    v_mfma_f32_32x32x16_bf16 v[40:55], a[88:91], a[80:83], v[40:55]
    v_mfma_f32_32x32x16_bf16 v[56:71], a[92:95], a[80:83], v[56:71]
L_join:
    s_lshl_b32 s56, s40, 2
    s_add_u32 s56, s56, 157440
    v_mov_b32 v128, s56
    s_nop 6
    s_nop 0
    v_pk_mul_f32 v[88:89], v[24:25], v[24:25]
    v_pk_mul_f32 v[90:91], v[26:27], v[26:27]
    v_pk_mul_f32 v[92:93], v[28:29], v[28:29]
    v_pk_mul_f32 v[94:95], v[30:31], v[30:31]
    v_pk_mul_f32 v[96:97], v[32:33], v[32:33]
    v_pk_mul_f32 v[98:99], v[34:35], v[34:35]
    v_pk_mul_f32 v[100:101], v[36:37], v[36:37]
    v_pk_mul_f32 v[102:103], v[38:39], v[38:39]
    v_pk_fma_f32 v[88:89], v[88:89], s[20:21], v[22:23]
    v_pk_fma_f32 v[90:91], v[90:91], s[20:21], v[22:23]
    v_pk_fma_f32 v[92:93], v[92:93], s[20:21], v[22:23]
    v_pk_fma_f32 v[94:95], v[94:95], s[20:21], v[22:23]
    v_pk_fma_f32 v[96:97], v[96:97], s[20:21], v[22:23]
    v_pk_fma_f32 v[98:99], v[98:99], s[20:21], v[22:23]
    v_pk_fma_f32 v[100:101], v[100:101], s[20:21], v[22:23]
    v_pk_fma_f32 v[102:103], v[102:103], s[20:21], v[22:23]
    v_pk_mul_f32 v[88:89], v[88:89], v[24:25]
    v_pk_mul_f32 v[90:91], v[90:91], v[26:27]
    v_pk_mul_f32 v[92:93], v[92:93], v[28:29]
    v_pk_mul_f32 v[94:95], v[94:95], v[30:31]
    v_pk_mul_f32 v[96:97], v[96:97], v[32:33]
    v_pk_mul_f32 v[98:99], v[98:99], v[34:35]
    v_pk_mul_f32 v[100:101], v[100:101], v[36:37]
    v_pk_mul_f32 v[102:103], v[102:103], v[38:39]
    v_exp_f32 v88, v88
    v_exp_f32 v89, v89
    v_exp_f32 v90, v90
    v_exp_f32 v91, v91
    v_exp_f32 v92, v92
    v_exp_f32 v93, v93
    v_exp_f32 v94, v94
    v_exp_f32 v95, v95
    v_exp_f32 v96, v96
    v_exp_f32 v97, v97
    v_exp_f32 v98, v98
    v_exp_f32 v99, v99
    v_exp_f32 v100, v100
    v_exp_f32 v101, v101
    v_exp_f32 v102, v102
    v_exp_f32 v103, v103
    v_pk_add_f32 v[88:89], v[88:89], 1.0 op_sel_hi:[1,0]
    v_pk_add_f32 v[90:91], v[90:91], 1.0 op_sel_hi:[1,0]
    v_pk_add_f32 v[92:93], v[92:93], 1.0 op_sel_hi:[1,0]
    v_pk_add_f32 v[94:95], v[94:95], 1.0 op_sel_hi:[1,0]
    v_pk_add_f32 v[96:97], v[96:97], 1.0 op_sel_hi:[1,0]
    v_pk_add_f32 v[98:99], v[98:99], 1.0 op_sel_hi:[1,0]
    v_pk_add_f32 v[100:101], v[100:101], 1.0 op_sel_hi:[1,0]
    v_pk_add_f32 v[102:103], v[102:103], 1.0 op_sel_hi:[1,0]
    v_rcp_f32 v88, v88
    v_rcp_f32 v89, v89
    v_rcp_f32 v90, v90
    v_rcp_f32 v91, v91
    v_rcp_f32 v92, v92
    v_rcp_f32 v93, v93
    v_rcp_f32 v94, v94
    v_rcp_f32 v95, v95
    v_rcp_f32 v96, v96
    v_rcp_f32 v97, v97
    v_rcp_f32 v98, v98
    v_rcp_f32 v99, v99
    v_rcp_f32 v100, v100
    v_rcp_f32 v101, v101
    v_rcp_f32 v102, v102
    v_rcp_f32 v103, v103
    v_pk_mul_f32 v[88:89], v[88:89], v[24:25]
    v_pk_mul_f32 v[90:91], v[90:91], v[26:27]
    v_pk_mul_f32 v[92:93], v[92:93], v[28:29]
    v_pk_mul_f32 v[94:95], v[94:95], v[30:31]
    v_pk_mul_f32 v[96:97], v[96:97], v[32:33]
    v_pk_mul_f32 v[98:99], v[98:99], v[34:35]
    v_pk_mul_f32 v[100:101], v[100:101], v[36:37]
    v_pk_mul_f32 v[102:103], v[102:103], v[38:39]
    v_cvt_pk_bf16_f32 v104, v88, v89
    v_cvt_pk_bf16_f32 v105, v90, v91
    v_cvt_pk_bf16_f32 v106, v92, v93
    v_cvt_pk_bf16_f32 v107, v94, v95
    v_cvt_pk_bf16_f32 v108, v96, v97
    v_cvt_pk_bf16_f32 v109, v98, v99
    v_cvt_pk_bf16_f32 v110, v100, v101
    v_cvt_pk_bf16_f32 v111, v102, v103
    buffer_store_dwordx4 v[104:107], v1, s[28:31], s61 offen offset:0 sc1
    buffer_store_dwordx4 v[108:111], v1, s[28:31], s61 offen offset:1024 sc1
    v_pk_mul_f32 v[88:89], v[40:41], v[40:41]
    v_pk_mul_f32 v[90:91], v[42:43], v[42:43]
    v_pk_mul_f32 v[92:93], v[44:45], v[44:45]
    v_pk_mul_f32 v[94:95], v[46:47], v[46:47]
    v_pk_mul_f32 v[96:97], v[48:49], v[48:49]
    v_pk_mul_f32 v[98:99], v[50:51], v[50:51]
    v_pk_mul_f32 v[100:101], v[52:53], v[52:53]
    v_pk_mul_f32 v[102:103], v[54:55], v[54:55]
    v_pk_fma_f32 v[88:89], v[88:89], s[20:21], v[22:23]
    v_pk_fma_f32 v[90:91], v[90:91], s[20:21], v[22:23]
    v_pk_fma_f32 v[92:93], v[92:93], s[20:21], v[22:23]
    v_pk_fma_f32 v[94:95], v[94:95], s[20:21], v[22:23]
    v_pk_fma_f32 v[96:97], v[96:97], s[20:21], v[22:23]
    v_pk_fma_f32 v[98:99], v[98:99], s[20:21], v[22:23]
    v_pk_fma_f32 v[100:101], v[100:101], s[20:21], v[22:23]
    v_pk_fma_f32 v[102:103], v[102:103], s[20:21], v[22:23]
    v_pk_mul_f32 v[88:89], v[88:89], v[40:41]
    v_pk_mul_f32 v[90:91], v[90:91], v[42:43]
    v_pk_mul_f32 v[92:93], v[92:93], v[44:45]
    v_pk_mul_f32 v[94:95], v[94:95], v[46:47]
    v_pk_mul_f32 v[96:97], v[96:97], v[48:49]
    v_pk_mul_f32 v[98:99], v[98:99], v[50:51]
    v_pk_mul_f32 v[100:101], v[100:101], v[52:53]
    v_pk_mul_f32 v[102:103], v[102:103], v[54:55]
    v_exp_f32 v88, v88
    v_exp_f32 v89, v89
    v_exp_f32 v90, v90
    v_exp_f32 v91, v91
    v_exp_f32 v92, v92
    v_exp_f32 v93, v93
    v_exp_f32 v94, v94
    v_exp_f32 v95, v95
    v_exp_f32 v96, v96
    v_exp_f32 v97, v97
    v_exp_f32 v98, v98
    v_exp_f32 v99, v99
    v_exp_f32 v100, v100
    v_exp_f32 v101, v101
    v_exp_f32 v102, v102
    v_exp_f32 v103, v103
    v_pk_add_f32 v[88:89], v[88:89], 1.0 op_sel_hi:[1,0]
    v_pk_add_f32 v[90:91], v[90:91], 1.0 op_sel_hi:[1,0]
    v_pk_add_f32 v[92:93], v[92:93], 1.0 op_sel_hi:[1,0]
    v_pk_add_f32 v[94:95], v[94:95], 1.0 op_sel_hi:[1,0]
    v_pk_add_f32 v[96:97], v[96:97], 1.0 op_sel_hi:[1,0]
    v_pk_add_f32 v[98:99], v[98:99], 1.0 op_sel_hi:[1,0]
    v_pk_add_f32 v[100:101], v[100:101], 1.0 op_sel_hi:[1,0]
    v_pk_add_f32 v[102:103], v[102:103], 1.0 op_sel_hi:[1,0]
    v_rcp_f32 v88, v88
    v_rcp_f32 v89, v89
    v_rcp_f32 v90, v90
    v_rcp_f32 v91, v91
    v_rcp_f32 v92, v92
    v_rcp_f32 v93, v93
    v_rcp_f32 v94, v94
    v_rcp_f32 v95, v95
    v_rcp_f32 v96, v96
    v_rcp_f32 v97, v97
    v_rcp_f32 v98, v98
    v_rcp_f32 v99, v99
    v_rcp_f32 v100, v100
    v_rcp_f32 v101, v101
    v_rcp_f32 v102, v102
    v_rcp_f32 v103, v103
    v_pk_mul_f32 v[88:89], v[88:89], v[40:41]
    v_pk_mul_f32 v[90:91], v[90:91], v[42:43]
    v_pk_mul_f32 v[92:93], v[92:93], v[44:45]
    v_pk_mul_f32 v[94:95], v[94:95], v[46:47]
    v_pk_mul_f32 v[96:97], v[96:97], v[48:49]
    v_pk_mul_f32 v[98:99], v[98:99], v[50:51]
    v_pk_mul_f32 v[100:101], v[100:101], v[52:53]
    v_pk_mul_f32 v[102:103], v[102:103], v[54:55]
    v_cvt_pk_bf16_f32 v112, v88, v89
    v_cvt_pk_bf16_f32 v113, v90, v91
    v_cvt_pk_bf16_f32 v114, v92, v93
    v_cvt_pk_bf16_f32 v115, v94, v95
    v_cvt_pk_bf16_f32 v116, v96, v97
    v_cvt_pk_bf16_f32 v117, v98, v99
    v_cvt_pk_bf16_f32 v118, v100, v101
    v_cvt_pk_bf16_f32 v119, v102, v103
    s_add_u32 s61, s61, 4096
    buffer_store_dwordx4 v[112:115], v1, s[28:31], s61 offen offset:0 sc1
    buffer_store_dwordx4 v[116:119], v1, s[28:31], s61 offen offset:1024 sc1
    v_pk_mul_f32 v[88:89], v[56:57], v[56:57]
    v_pk_mul_f32 v[90:91], v[58:59], v[58:59]
    v_pk_mul_f32 v[92:93], v[60:61], v[60:61]
    v_pk_mul_f32 v[94:95], v[62:63], v[62:63]
    v_pk_mul_f32 v[96:97], v[64:65], v[64:65]
    v_pk_mul_f32 v[98:99], v[66:67], v[66:67]
    v_pk_mul_f32 v[100:101], v[68:69], v[68:69]
    v_pk_mul_f32 v[102:103], v[70:71], v[70:71]
    v_pk_fma_f32 v[88:89], v[88:89], s[20:21], v[22:23]
    v_pk_fma_f32 v[90:91], v[90:91], s[20:21], v[22:23]
    v_pk_fma_f32 v[92:93], v[92:93], s[20:21], v[22:23]
    v_pk_fma_f32 v[94:95], v[94:95], s[20:21], v[22:23]
    v_pk_fma_f32 v[96:97], v[96:97], s[20:21], v[22:23]
    v_pk_fma_f32 v[98:99], v[98:99], s[20:21], v[22:23]
    v_pk_fma_f32 v[100:101], v[100:101], s[20:21], v[22:23]
    v_pk_fma_f32 v[102:103], v[102:103], s[20:21], v[22:23]
    v_pk_mul_f32 v[88:89], v[88:89], v[56:57]
    v_pk_mul_f32 v[90:91], v[90:91], v[58:59]
    v_pk_mul_f32 v[92:93], v[92:93], v[60:61]
    v_pk_mul_f32 v[94:95], v[94:95], v[62:63]
    v_pk_mul_f32 v[96:97], v[96:97], v[64:65]
    v_pk_mul_f32 v[98:99], v[98:99], v[66:67]
    v_pk_mul_f32 v[100:101], v[100:101], v[68:69]
    v_pk_mul_f32 v[102:103], v[102:103], v[70:71]
    v_exp_f32 v88, v88
    v_exp_f32 v89, v89
    v_exp_f32 v90, v90
    v_exp_f32 v91, v91
    v_exp_f32 v92, v92
    v_exp_f32 v93, v93
    v_exp_f32 v94, v94
    v_exp_f32 v95, v95
    v_exp_f32 v96, v96
    v_exp_f32 v97, v97
    v_exp_f32 v98, v98
    v_exp_f32 v99, v99
    v_exp_f32 v100, v100
    v_exp_f32 v101, v101
    v_exp_f32 v102, v102
    v_exp_f32 v103, v103
    v_pk_add_f32 v[88:89], v[88:89], 1.0 op_sel_hi:[1,0]
    v_pk_add_f32 v[90:91], v[90:91], 1.0 op_sel_hi:[1,0]
    v_pk_add_f32 v[92:93], v[92:93], 1.0 op_sel_hi:[1,0]
    v_pk_add_f32 v[94:95], v[94:95], 1.0 op_sel_hi:[1,0]
    v_pk_add_f32 v[96:97], v[96:97], 1.0 op_sel_hi:[1,0]
    v_pk_add_f32 v[98:99], v[98:99], 1.0 op_sel_hi:[1,0]
    v_pk_add_f32 v[100:101], v[100:101], 1.0 op_sel_hi:[1,0]
    v_pk_add_f32 v[102:103], v[102:103], 1.0 op_sel_hi:[1,0]
    v_rcp_f32 v88, v88
    v_rcp_f32 v89, v89
    v_rcp_f32 v90, v90
    v_rcp_f32 v91, v91
    v_rcp_f32 v92, v92
    v_rcp_f32 v93, v93
    v_rcp_f32 v94, v94
    v_rcp_f32 v95, v95
    v_rcp_f32 v96, v96
    v_rcp_f32 v97, v97
    v_rcp_f32 v98, v98
    v_rcp_f32 v99, v99
    v_rcp_f32 v100, v100
    v_rcp_f32 v101, v101
    v_rcp_f32 v102, v102
    v_rcp_f32 v103, v103
    v_pk_mul_f32 v[88:89], v[88:89], v[56:57]
    v_pk_mul_f32 v[90:91], v[90:91], v[58:59]
    v_pk_mul_f32 v[92:93], v[92:93], v[60:61]
    v_pk_mul_f32 v[94:95], v[94:95], v[62:63]
    v_pk_mul_f32 v[96:97], v[96:97], v[64:65]
    v_pk_mul_f32 v[98:99], v[98:99], v[66:67]
    v_pk_mul_f32 v[100:101], v[100:101], v[68:69]
    v_pk_mul_f32 v[102:103], v[102:103], v[70:71]
    ds_write_b32 v128, v128 offset:32
    v_cvt_pk_bf16_f32 v120, v88, v89
    v_cvt_pk_bf16_f32 v121, v90, v91
    v_cvt_pk_bf16_f32 v122, v92, v93
    v_cvt_pk_bf16_f32 v123, v94, v95
    v_cvt_pk_bf16_f32 v124, v96, v97
    v_cvt_pk_bf16_f32 v125, v98, v99
    v_cvt_pk_bf16_f32 v126, v100, v101
    v_cvt_pk_bf16_f32 v127, v102, v103
    s_add_u32 s61, s61, 4096
    s_waitcnt vmcnt(2)
    v_add_u32 v10, 3, v4
    s_mov_b64 exec, 1
    buffer_store_dword v10, v3, s[28:31], s8 offen sc1
    s_mov_b64 exec, -1
    buffer_store_dwordx4 v[120:123], v13, s[28:31], s61 offen offset:0 sc1
    buffer_store_dwordx4 v[124:127], v13, s[28:31], s61 offen offset:1024 sc1
    v_mov_b32 v128, 157440
    v_add_u32_e64 v6, 0, v143
    v_add_u32 v7, 7168, v143
    v_add_u32 v8, 14336, v143
    v_add_u32 v9, 21504, v143
    s_lshl_b32 s56, s40, 2
    v_add_u32 v128, s56, v128
    s_mov_b32 s60, 0
    s_mov_b32 s23, 0
L_gw:
    ds_read_b32 v129, v128 offset:16
    s_add_u32 s60, s60, 1
    s_waitcnt lgkmcnt(0)
    v_cmp_ne_u32 vcc, 1, v129
    s_cbranch_vccz L_gw_ok
    s_cmp_lg_u32 s23, 0
    s_cbranch_scc1 L_gw2
    s_waitcnt vmcnt(0)
    v_add_u32 v10, 3, v4
    s_mov_b64 exec, 1
    buffer_store_dword v10, v3, s[28:31], s62 offen sc1
    s_mov_b64 exec, -1
    s_mov_b32 s23, 1
L_gw2:
    s_sleep 1
    s_cmp_lt_u32 s60, 0x40000
    s_cbranch_scc1 L_gw
L_gw_ok:
    s_nop 0
    ds_read_b64_tr_b16 a[0:1], v14 offset:0
    ds_read_b64_tr_b16 a[2:3], v14 offset:1024
    ds_read_b64_tr_b16 a[4:5], v14 offset:2048
    ds_read_b64_tr_b16 a[6:7], v14 offset:3072
    ds_read_b64_tr_b16 a[8:9], v15 offset:0
    ds_read_b64_tr_b16 a[10:11], v15 offset:1024
    ds_read_b64_tr_b16 a[12:13], v15 offset:2048
    ds_read_b64_tr_b16 a[14:15], v15 offset:3072
    ds_read_b64_tr_b16 a[16:17], v14 offset:4096
    ds_read_b64_tr_b16 a[18:19], v14 offset:5120
    ds_read_b64_tr_b16 a[20:21], v14 offset:6144
    ds_read_b64_tr_b16 a[22:23], v14 offset:7168
    ds_read_b64_tr_b16 a[24:25], v15 offset:4096
    ds_read_b64_tr_b16 a[26:27], v15 offset:5120
    ds_read_b64_tr_b16 a[28:29], v15 offset:6144
    ds_read_b64_tr_b16 a[30:31], v15 offset:7168
    ds_read_b64_tr_b16 a[32:33], v14 offset:8192
    ds_read_b64_tr_b16 a[34:35], v14 offset:9216
    ds_read_b64_tr_b16 a[36:37], v14 offset:10240
    ds_read_b64_tr_b16 a[38:39], v14 offset:11264
    ds_read_b64_tr_b16 a[40:41], v15 offset:8192
    ds_read_b64_tr_b16 a[42:43], v15 offset:9216
    ds_read_b64_tr_b16 a[44:45], v15 offset:10240
    ds_read_b64_tr_b16 a[46:47], v15 offset:11264
    ds_read_b64_tr_b16 a[48:49], v16 offset:0
    ds_read_b64_tr_b16 a[50:51], v16 offset:1024
    ds_read_b64_tr_b16 a[52:53], v16 offset:2048
    ds_read_b64_tr_b16 a[54:55], v16 offset:3072
    ds_read_b64_tr_b16 a[56:57], v17 offset:0
    ds_read_b64_tr_b16 a[58:59], v17 offset:1024
    ds_read_b64_tr_b16 a[60:61], v17 offset:2048
    ds_read_b64_tr_b16 a[62:63], v17 offset:3072
    ds_read_b64_tr_b16 a[64:65], v16 offset:4096
    ds_read_b64_tr_b16 a[66:67], v16 offset:5120
    ds_read_b64_tr_b16 a[68:69], v16 offset:6144
    ds_read_b64_tr_b16 a[70:71], v16 offset:7168
    ds_read_b64_tr_b16 a[72:73], v17 offset:4096
    ds_read_b64_tr_b16 a[74:75], v17 offset:5120
    ds_read_b64_tr_b16 a[76:77], v17 offset:6144
    ds_read_b64_tr_b16 a[78:79], v17 offset:7168
    s_waitcnt lgkmcnt(15)
    s_mov_b32 s97, 229376
    s_add_u32 m0, s50, 0
    s_nop 0
    s_nop 0
    buffer_load_dwordx4 v6, s[24:27], s97 offen offset:0 lds
    buffer_load_dwordx4 v7, s[24:27], s97 offen offset:1024 lds
    buffer_load_dwordx4 v8, s[24:27], s97 offen offset:2048 lds
    buffer_load_dwordx4 v9, s[24:27], s97 offen offset:3072 lds
    s_mov_b32 s97, 327680
    s_add_u32 m0, s50, 4096
    s_nop 0
    buffer_load_dwordx4 v6, s[24:27], s97 offen offset:0 lds
    buffer_load_dwordx4 v7, s[24:27], s97 offen offset:1024 lds
    buffer_load_dwordx4 v8, s[24:27], s97 offen offset:2048 lds
    buffer_load_dwordx4 v9, s[24:27], s97 offen offset:3072 lds
    s_waitcnt vmcnt(8)
    s_cmp_lg_u32 s23, 0
    s_cbranch_scc1 L_gw3
    v_add_u32 v10, 3, v4
    s_mov_b64 exec, 1
    buffer_store_dword v10, v3, s[28:31], s62 offen sc1
    s_mov_b64 exec, -1
L_gw3:
    s_mov_b32 s97, 65536
    s_add_u32 m0, s50, 8192
    s_nop 0
    buffer_load_dwordx4 v6, s[24:27], s97 offen offset:0 lds
    buffer_load_dwordx4 v7, s[24:27], s97 offen offset:1024 lds
    buffer_load_dwordx4 v8, s[24:27], s97 offen offset:2048 lds
    buffer_load_dwordx4 v9, s[24:27], s97 offen offset:3072 lds
    s_waitcnt lgkmcnt(8)
    s_mov_b32 s97, 163840
    s_add_u32 m0, s94, 65536
    s_nop 0
    buffer_load_dwordx4 v6, s[24:27], s97 offen offset:0 lds
    buffer_load_dwordx4 v7, s[24:27], s97 offen offset:1024 lds
    buffer_load_dwordx4 v8, s[24:27], s97 offen offset:2048 lds
    buffer_load_dwordx4 v9, s[24:27], s97 offen offset:3072 lds
    s_waitcnt lgkmcnt(0)
    s_mov_b32 s97, 262144
    s_add_u32 m0, s94, 69632
    s_nop 0
    buffer_load_dwordx4 v6, s[24:27], s97 offen offset:0 lds
    buffer_load_dwordx4 v7, s[24:27], s97 offen offset:1024 lds
    buffer_load_dwordx4 v8, s[24:27], s97 offen offset:2048 lds
    buffer_load_dwordx4 v9, s[24:27], s97 offen offset:3072 lds
    buffer_load_dword v5, v12, s[28:31], s9 offen sc1
    v_add_u32_e64 v6, s50, v1
    v_xor_b32 v7, 16384, v6
    v_xor_b32 v8, 32768, v6
    v_xor_b32 v9, 49152, v6
    s_lshl_b32 s56, s53, 11
    v_add_u32 v10, s56, v1
    v_xor_b32 v13, 2048, v10
    s_add_u32 s57, s47, 3
    s_waitcnt vmcnt(0)
    s_mov_b32 s60, 0
L_f2:
    v_cmp_ne_u32 vcc, s57, v5
    s_nop 0
    s_and_b64 vcc, vcc, -1
    s_cbranch_scc0 L_f2_ok
    s_sleep 4
    buffer_load_dword v5, v12, s[28:31], s9 offen sc1
    s_add_u32 s60, s60, 1
    s_cmp_lt_u32 s60, 32768
    s_waitcnt vmcnt(0)
    s_cbranch_scc1 L_f2
L_f2_ok:
    buffer_load_dwordx2 v[22:23], v11, s[28:31], s89 offen sc1
    s_mov_b32 s95, 0
    buffer_load_dwordx4 v[88:91], v13, s[36:39], s95 offen offset:0 sc1
    buffer_load_dwordx4 v[92:95], v13, s[36:39], s95 offen offset:1024 sc1
    s_mov_b32 s95, 0
    s_nop 0
    buffer_load_dwordx4 v[96:99], v10, s[36:39], s95 offen offset:0 sc1
    buffer_load_dwordx4 v[100:103], v10, s[36:39], s95 offen offset:1024 sc1
    s_mov_b32 s95, 12288
    buffer_load_dwordx4 v[104:107], v13, s[36:39], s95 offen offset:0 sc1
    buffer_load_dwordx4 v[108:111], v13, s[36:39], s95 offen offset:1024 sc1
    s_mov_b32 s95, 12288
    buffer_load_dwordx4 v[112:115], v10, s[36:39], s95 offen offset:0 sc1
    buffer_load_dwordx4 v[116:119], v10, s[36:39], s95 offen offset:1024 sc1
    s_setprio 0
    s_nop 0
    ds_read_b64_tr_b16 a[80:81], v14 offset:12288
    ds_read_b64_tr_b16 a[82:83], v14 offset:13312
    ds_read_b64_tr_b16 a[84:85], v14 offset:14336
    ds_read_b64_tr_b16 a[86:87], v14 offset:15360
    ds_read_b64_tr_b16 a[88:89], v15 offset:12288
    ds_read_b64_tr_b16 a[90:91], v15 offset:13312
    ds_read_b64_tr_b16 a[92:93], v15 offset:14336
    ds_read_b64_tr_b16 a[94:95], v15 offset:15360
    s_waitcnt vmcnt(7)
    v_mfma_f32_32x32x16_bf16 v[40:55], a[0:3], v[88:91], 0
    v_mfma_f32_32x32x16_bf16 v[56:71], a[8:11], v[88:91], 0
    s_mov_b32 s95, 24576
    buffer_load_dwordx4 v[88:91], v13, s[36:39], s95 offen offset:0 sc1
    s_waitcnt vmcnt(7)
    v_mfma_f32_32x32x16_bf16 v[40:55], a[4:7], v[92:95], v[40:55]
    v_mfma_f32_32x32x16_bf16 v[56:71], a[12:15], v[92:95], v[56:71]
    buffer_load_dwordx4 v[92:95], v13, s[36:39], s95 offen offset:1024 sc1
    s_waitcnt vmcnt(7)
    v_mfma_f32_32x32x16_bf16 v[72:87], a[0:3], v[96:99], v[72:87]
    ds_read_b64_tr_b16 a[96:97], v14 offset:0
    ds_read_b64_tr_b16 a[98:99], v14 offset:1024
    v_mfma_f32_32x32x16_bf16 v[24:39], a[8:11], v[96:99], 0
    s_mov_b32 s95, 24576
    buffer_load_dwordx4 v[96:99], v10, s[36:39], s95 offen offset:0 sc1
    ds_read_b64_tr_b16 a[100:101], v14 offset:2048
    ds_read_b64_tr_b16 a[102:103], v14 offset:3072
    s_waitcnt vmcnt(7)
    v_mfma_f32_32x32x16_bf16 v[72:87], a[4:7], v[100:103], v[72:87]
    ds_read_b64_tr_b16 a[104:105], v15 offset:0
    ds_read_b64_tr_b16 a[106:107], v15 offset:1024
    v_mfma_f32_32x32x16_bf16 v[24:39], a[12:15], v[100:103], v[24:39]
    buffer_load_dwordx4 v[100:103], v10, s[36:39], s95 offen offset:1024 sc1
    ds_read_b64_tr_b16 a[108:109], v15 offset:2048
    ds_read_b64_tr_b16 a[110:111], v15 offset:3072
    s_waitcnt vmcnt(7)
    v_mfma_f32_32x32x16_bf16 v[40:55], a[16:19], v[104:107], v[40:55]
    v_mfma_f32_32x32x16_bf16 v[56:71], a[24:27], v[104:107], v[56:71]
    buffer_load_dword v5, v12, s[28:31], s88 offen sc1
    s_mov_b32 s95, 36864
    buffer_load_dwordx4 v[104:107], v13, s[36:39], s95 offen offset:0 sc1
    s_waitcnt vmcnt(8)
    v_mfma_f32_32x32x16_bf16 v[40:55], a[20:23], v[108:111], v[40:55]
    v_mfma_f32_32x32x16_bf16 v[56:71], a[28:31], v[108:111], v[56:71]
    buffer_load_dwordx4 v[108:111], v13, s[36:39], s95 offen offset:1024 sc1
    s_waitcnt vmcnt(8)
    v_mfma_f32_32x32x16_bf16 v[72:87], a[16:19], v[112:115], v[72:87]
    ds_read_b64_tr_b16 a[0:1], v14 offset:4096
    ds_read_b64_tr_b16 a[2:3], v14 offset:5120
    v_mfma_f32_32x32x16_bf16 v[24:39], a[24:27], v[112:115], v[24:39]
    s_mov_b32 s95, 36864
    buffer_load_dwordx4 v[112:115], v10, s[36:39], s95 offen offset:0 sc1
    ds_read_b64_tr_b16 a[4:5], v14 offset:6144
    ds_read_b64_tr_b16 a[6:7], v14 offset:7168
    s_waitcnt vmcnt(8)
    v_mfma_f32_32x32x16_bf16 v[72:87], a[20:23], v[116:119], v[72:87]
    ds_read_b64_tr_b16 a[8:9], v15 offset:4096
    ds_read_b64_tr_b16 a[10:11], v15 offset:5120
    v_mfma_f32_32x32x16_bf16 v[24:39], a[28:31], v[116:119], v[24:39]
    buffer_load_dwordx4 v[116:119], v10, s[36:39], s95 offen offset:1024 sc1
    ds_read_b64_tr_b16 a[12:13], v15 offset:6144
    ds_read_b64_tr_b16 a[14:15], v15 offset:7168
    s_waitcnt vmcnt(8)
    v_mfma_f32_32x32x16_bf16 v[40:55], a[32:35], v[88:91], v[40:55]
    v_mfma_f32_32x32x16_bf16 v[56:71], a[40:43], v[88:91], v[56:71]
    s_waitcnt vmcnt(4)
    s_mov_b32 s60, 0
L_f2b:
    v_cmp_ne_u32 vcc, s57, v5
    s_nop 0
    s_and_b64 vcc, vcc, -1
    s_cbranch_scc0 L_f2b_ok
    s_sleep 4
    buffer_load_dword v5, v12, s[28:31], s88 offen sc1
    s_add_u32 s60, s60, 1
    s_cmp_lt_u32 s60, 32768
    s_waitcnt vmcnt(0)
    s_cbranch_scc1 L_f2b
L_f2b_ok:
    s_mov_b32 s95, 4096
    buffer_load_dwordx4 v[88:91], v13, s[36:39], s95 offen offset:0 sc1
    v_mfma_f32_32x32x16_bf16 v[40:55], a[36:39], v[92:95], v[40:55]
    v_mfma_f32_32x32x16_bf16 v[56:71], a[44:47], v[92:95], v[56:71]
    buffer_load_dwordx4 v[92:95], v13, s[36:39], s95 offen offset:1024 sc1
    v_mfma_f32_32x32x16_bf16 v[72:87], a[32:35], v[96:99], v[72:87]
    ds_read_b64_tr_b16 a[16:17], v14 offset:8192
    ds_read_b64_tr_b16 a[18:19], v14 offset:9216
    v_mfma_f32_32x32x16_bf16 v[24:39], a[40:43], v[96:99], v[24:39]
    s_mov_b32 s95, 16384
    buffer_load_dwordx4 v[96:99], v13, s[36:39], s95 offen offset:0 sc1
    ds_read_b64_tr_b16 a[20:21], v14 offset:10240
    ds_read_b64_tr_b16 a[22:23], v14 offset:11264
    v_mfma_f32_32x32x16_bf16 v[72:87], a[36:39], v[100:103], v[72:87]
    ds_read_b64_tr_b16 a[24:25], v15 offset:8192
    ds_read_b64_tr_b16 a[26:27], v15 offset:9216
    v_mfma_f32_32x32x16_bf16 v[24:39], a[44:47], v[100:103], v[24:39]
    buffer_load_dwordx4 v[100:103], v13, s[36:39], s95 offen offset:1024 sc1
    ds_read_b64_tr_b16 a[28:29], v15 offset:10240
    ds_read_b64_tr_b16 a[30:31], v15 offset:11264
    s_waitcnt vmcnt(7)
    v_mfma_f32_32x32x16_bf16 v[40:55], a[48:51], v[104:107], v[40:55]
    v_mfma_f32_32x32x16_bf16 v[56:71], a[56:59], v[104:107], v[56:71]
    s_mov_b32 s95, 28672
    buffer_load_dwordx4 v[104:107], v13, s[36:39], s95 offen offset:0 sc1
    s_waitcnt vmcnt(7)
    v_mfma_f32_32x32x16_bf16 v[40:55], a[52:55], v[108:111], v[40:55]
    v_mfma_f32_32x32x16_bf16 v[56:71], a[60:63], v[108:111], v[56:71]
    buffer_load_dwordx4 v[108:111], v13, s[36:39], s95 offen offset:1024 sc1
    s_waitcnt vmcnt(7)
    v_mfma_f32_32x32x16_bf16 v[72:87], a[48:51], v[112:115], v[72:87]
    ds_read_b64_tr_b16 a[32:33], v16 offset:0
    ds_read_b64_tr_b16 a[34:35], v16 offset:1024
    v_mfma_f32_32x32x16_bf16 v[24:39], a[56:59], v[112:115], v[24:39]
    s_mov_b32 s95, 40960
    buffer_load_dwordx4 v[112:115], v13, s[36:39], s95 offen offset:0 sc1
    ds_read_b64_tr_b16 a[36:37], v16 offset:2048
    ds_read_b64_tr_b16 a[38:39], v16 offset:3072
    s_waitcnt vmcnt(7)
    v_mfma_f32_32x32x16_bf16 v[72:87], a[52:55], v[116:119], v[72:87]
    ds_read_b64_tr_b16 a[40:41], v17 offset:0
    ds_read_b64_tr_b16 a[42:43], v17 offset:1024
    v_mfma_f32_32x32x16_bf16 v[24:39], a[60:63], v[116:119], v[24:39]
    buffer_load_dwordx4 v[116:119], v13, s[36:39], s95 offen offset:1024 sc1
    ds_read_b64_tr_b16 a[44:45], v17 offset:2048
    ds_read_b64_tr_b16 a[46:47], v17 offset:3072
    s_waitcnt vmcnt(7)
    v_mfma_f32_32x32x16_bf16 v[40:55], a[64:67], v[88:91], v[40:55]
    v_mfma_f32_32x32x16_bf16 v[56:71], a[72:75], v[88:91], v[56:71]
    s_mov_b32 s95, 8192
    buffer_load_dwordx4 v[88:91], v13, s[36:39], s95 offen offset:0 sc1
    s_waitcnt vmcnt(7)
    v_mfma_f32_32x32x16_bf16 v[40:55], a[68:71], v[92:95], v[40:55]
    v_mfma_f32_32x32x16_bf16 v[56:71], a[76:79], v[92:95], v[56:71]
    buffer_load_dwordx4 v[92:95], v13, s[36:39], s95 offen offset:1024 sc1
    s_waitcnt vmcnt(7)
    s_waitcnt lgkmcnt(15)
    v_mfma_f32_32x32x16_bf16 v[40:55], a[80:83], v[96:99], v[40:55]
    ds_read_b64_tr_b16 a[48:49], v16 offset:4096
    ds_read_b64_tr_b16 a[50:51], v16 offset:5120
    v_mfma_f32_32x32x16_bf16 v[56:71], a[88:91], v[96:99], v[56:71]
    s_mov_b32 s95, 20480
    buffer_load_dwordx4 v[96:99], v13, s[36:39], s95 offen offset:0 sc1
    ds_read_b64_tr_b16 a[52:53], v16 offset:6144
    ds_read_b64_tr_b16 a[54:55], v16 offset:7168
    s_waitcnt vmcnt(7)
    v_mfma_f32_32x32x16_bf16 v[40:55], a[84:87], v[100:103], v[40:55]
    ds_read_b64_tr_b16 a[56:57], v17 offset:4096
    ds_read_b64_tr_b16 a[58:59], v17 offset:5120
    v_mfma_f32_32x32x16_bf16 v[56:71], a[92:95], v[100:103], v[56:71]
    buffer_load_dwordx4 v[100:103], v13, s[36:39], s95 offen offset:1024 sc1
    ds_read_b64_tr_b16 a[60:61], v17 offset:6144
    ds_read_b64_tr_b16 a[62:63], v17 offset:7168
    s_waitcnt vmcnt(7)
    v_mfma_f32_32x32x16_bf16 v[40:55], a[96:99], v[104:107], v[40:55]
    v_mfma_f32_32x32x16_bf16 v[56:71], a[104:107], v[104:107], v[56:71]
    s_mov_b32 s95, 32768
    buffer_load_dwordx4 v[104:107], v13, s[36:39], s95 offen offset:0 sc1
    s_waitcnt vmcnt(7)
    v_mfma_f32_32x32x16_bf16 v[40:55], a[100:103], v[108:111], v[40:55]
    v_mfma_f32_32x32x16_bf16 v[56:71], a[108:111], v[108:111], v[56:71]
    buffer_load_dwordx4 v[108:111], v13, s[36:39], s95 offen offset:1024 sc1
    s_waitcnt vmcnt(7)
    v_mfma_f32_32x32x16_bf16 v[40:55], a[0:3], v[112:115], v[40:55]
    v_mfma_f32_32x32x16_bf16 v[56:71], a[8:11], v[112:115], v[56:71]
    s_mov_b32 s95, 32768
    buffer_load_dwordx4 v[112:115], v10, s[36:39], s95 offen offset:0 sc1
    s_waitcnt vmcnt(7)
    v_mfma_f32_32x32x16_bf16 v[40:55], a[4:7], v[116:119], v[40:55]
    v_mfma_f32_32x32x16_bf16 v[56:71], a[12:15], v[116:119], v[56:71]
    buffer_load_dwordx4 v[116:119], v10, s[36:39], s95 offen offset:1024 sc1
    s_waitcnt vmcnt(7)
    s_waitcnt lgkmcnt(15)
    v_mfma_f32_32x32x16_bf16 v[40:55], a[16:19], v[88:91], v[40:55]
    v_mfma_f32_32x32x16_bf16 v[56:71], a[24:27], v[88:91], v[56:71]
    s_mov_b32 s95, 20480
    buffer_load_dwordx4 v[88:91], v10, s[36:39], s95 offen offset:0 sc1
    s_waitcnt vmcnt(7)
    v_mfma_f32_32x32x16_bf16 v[40:55], a[20:23], v[92:95], v[40:55]
    v_mfma_f32_32x32x16_bf16 v[56:71], a[28:31], v[92:95], v[56:71]
    buffer_load_dwordx4 v[92:95], v10, s[36:39], s95 offen offset:1024 sc1
    s_waitcnt vmcnt(7)
    s_waitcnt lgkmcnt(8)
    v_mfma_f32_32x32x16_bf16 v[40:55], a[32:35], v[96:99], v[40:55]
    v_mfma_f32_32x32x16_bf16 v[56:71], a[40:43], v[96:99], v[56:71]
    s_mov_b32 s95, 8192
    buffer_load_dwordx4 v[96:99], v10, s[36:39], s95 offen offset:0 sc1
    s_waitcnt vmcnt(7)
    v_mfma_f32_32x32x16_bf16 v[40:55], a[36:39], v[100:103], v[40:55]
    v_mfma_f32_32x32x16_bf16 v[56:71], a[44:47], v[100:103], v[56:71]
    buffer_load_dwordx4 v[100:103], v10, s[36:39], s95 offen offset:1024 sc1
    s_waitcnt vmcnt(7)
    s_waitcnt lgkmcnt(0)
    v_mfma_f32_32x32x16_bf16 v[40:55], a[48:51], v[104:107], v[40:55]
    v_mfma_f32_32x32x16_bf16 v[56:71], a[56:59], v[104:107], v[56:71]
    s_mov_b32 s95, 40960
    buffer_load_dwordx4 v[104:107], v10, s[36:39], s95 offen offset:0 sc1
    s_waitcnt vmcnt(7)
    v_mfma_f32_32x32x16_bf16 v[40:55], a[52:55], v[108:111], v[40:55]
    v_mfma_f32_32x32x16_bf16 v[56:71], a[60:63], v[108:111], v[56:71]
    buffer_load_dwordx4 v[108:111], v10, s[36:39], s95 offen offset:1024 sc1
    s_waitcnt vmcnt(7)
    v_mfma_f32_32x32x16_bf16 v[72:87], a[48:51], v[112:115], v[72:87]
    v_mfma_f32_32x32x16_bf16 v[24:39], a[56:59], v[112:115], v[24:39]
    s_mov_b32 s95, 28672
    buffer_load_dwordx4 v[112:115], v10, s[36:39], s95 offen offset:0 sc1
    s_waitcnt vmcnt(7)
    v_mfma_f32_32x32x16_bf16 v[72:87], a[52:55], v[116:119], v[72:87]
    s_nop 3
    ds_write_b128 v6, v[56:59] offset:8192
    v_mfma_f32_32x32x16_bf16 v[24:39], a[60:63], v[116:119], v[24:39]
    buffer_load_dwordx4 v[116:119], v10, s[36:39], s95 offen offset:1024 sc1
    s_waitcnt vmcnt(7)
    v_mfma_f32_32x32x16_bf16 v[72:87], a[32:35], v[88:91], v[72:87]
    ds_write_b128 v6, v[60:63] offset:9216
    v_mfma_f32_32x32x16_bf16 v[24:39], a[40:43], v[88:91], v[24:39]
    s_mov_b32 s95, 16384
    buffer_load_dwordx4 v[88:91], v10, s[36:39], s95 offen offset:0 sc1
    s_waitcnt vmcnt(7)
    v_mfma_f32_32x32x16_bf16 v[72:87], a[36:39], v[92:95], v[72:87]
    ds_write_b128 v6, v[64:67] offset:10240
    v_mfma_f32_32x32x16_bf16 v[24:39], a[44:47], v[92:95], v[24:39]
    buffer_load_dwordx4 v[92:95], v10, s[36:39], s95 offen offset:1024 sc1
    s_waitcnt vmcnt(7)
    v_mfma_f32_32x32x16_bf16 v[72:87], a[16:19], v[96:99], v[72:87]
    ds_write_b128 v6, v[68:71] offset:11264
    v_mfma_f32_32x32x16_bf16 v[24:39], a[24:27], v[96:99], v[24:39]
    s_mov_b32 s95, 4096
    buffer_load_dwordx4 v[96:99], v10, s[36:39], s95 offen offset:0 sc1
    s_waitcnt vmcnt(7)
    v_mfma_f32_32x32x16_bf16 v[72:87], a[20:23], v[100:103], v[72:87]
    ds_write_b128 v6, v[40:43] offset:4096
    v_mfma_f32_32x32x16_bf16 v[24:39], a[28:31], v[100:103], v[24:39]
    buffer_load_dwordx4 v[100:103], v10, s[36:39], s95 offen offset:1024 sc1
    s_waitcnt vmcnt(7)
    v_mfma_f32_32x32x16_bf16 v[72:87], a[0:3], v[104:107], v[72:87]
    s_mov_b32 m0, s58
    s_nop 0
    buffer_load_dwordx4 v20, s[4:7], s90 offen lds
    buffer_load_dwordx4 v20, s[4:7], s59 offen offset:1024 lds
    ds_write_b128 v6, v[44:47] offset:5120
    v_mfma_f32_32x32x16_bf16 v[24:39], a[8:11], v[104:107], v[24:39]
    s_waitcnt vmcnt(8)
    v_mfma_f32_32x32x16_bf16 v[72:87], a[4:7], v[108:111], v[72:87]
    ds_write_b128 v6, v[48:51] offset:6144
    v_mfma_f32_32x32x16_bf16 v[24:39], a[12:15], v[108:111], v[24:39]
    s_waitcnt vmcnt(7)
    v_mfma_f32_32x32x16_bf16 v[72:87], a[96:99], v[112:115], v[72:87]
    ds_write_b128 v6, v[52:55] offset:7168
    v_mfma_f32_32x32x16_bf16 v[24:39], a[104:107], v[112:115], v[24:39]
    s_waitcnt vmcnt(6)
    v_mfma_f32_32x32x16_bf16 v[72:87], a[100:103], v[116:119], v[72:87]
    v_and_b32 v12, 0xf0, v1
    buffer_load_dword v5, v12, s[28:31], s55 offen sc1
    v_mfma_f32_32x32x16_bf16 v[24:39], a[108:111], v[116:119], v[24:39]
    s_waitcnt vmcnt(6)
    v_mfma_f32_32x32x16_bf16 v[72:87], a[80:83], v[88:91], v[72:87]
    v_mfma_f32_32x32x16_bf16 v[24:39], a[88:91], v[88:91], v[24:39]
    v_xor_b32 v15, 16, v18
    v_xor_b32 v16, 32, v18
    v_xor_b32 v17, 48, v18
    s_waitcnt vmcnt(5)
    v_mfma_f32_32x32x16_bf16 v[72:87], a[84:87], v[92:95], v[72:87]
    v_mfma_f32_32x32x16_bf16 v[24:39], a[92:95], v[92:95], v[24:39]
    s_waitcnt vmcnt(4)
    v_mfma_f32_32x32x16_bf16 v[72:87], a[64:67], v[96:99], v[72:87]
    v_mfma_f32_32x32x16_bf16 v[24:39], a[72:75], v[96:99], v[24:39]
    s_waitcnt vmcnt(3)
    v_mfma_f32_32x32x16_bf16 v[72:87], a[68:71], v[100:103], v[72:87]
    v_mfma_f32_32x32x16_bf16 v[24:39], a[76:79], v[100:103], v[24:39]
    s_nop 11
    ds_write_b128 v6, v[24:27] offset:0
    ds_write_b128 v6, v[28:31] offset:1024
    ds_write_b128 v6, v[32:35] offset:2048
    ds_write_b128 v6, v[36:39] offset:3072
    s_waitcnt vmcnt(1)
    ds_read_b64 v[112:113], v18
    ds_read_b64 v[114:115], v15
    ds_read_b64 v[116:117], v16
    ds_read_b64 v[118:119], v17
    s_waitcnt vmcnt(0)
    s_mov_b32 s60, 0
L_f3:
    v_cmp_ne_u32 vcc, s47, v5
    s_nop 0
    s_and_b64 vcc, vcc, -1
    s_cbranch_scc0 L_f3_ok
    s_sleep 4
    buffer_load_dword v5, v12, s[28:31], s55 offen sc1
    s_add_u32 s60, s60, 1
    s_cmp_lt_u32 s60, 32768
    s_waitcnt vmcnt(0)
    s_cbranch_scc1 L_f3
L_f3_ok:
    s_nop 0
    buffer_load_dword v136, v21, s[28:31], s12 offen sc1
    buffer_load_dword v137, v21, s[28:31], s13 offen sc1
    buffer_load_dword v138, v21, s[28:31], s14 offen sc1
    buffer_load_dword v139, v21, s[28:31], s15 offen sc1
    buffer_load_dword v140, v21, s[28:31], s16 offen sc1
    buffer_load_dword v141, v21, s[28:31], s17 offen sc1
    buffer_load_dword v142, v21, s[28:31], s18 offen sc1
    buffer_load_dword v143, v21, s[28:31], s19 offen sc1
    s_waitcnt lgkmcnt(0)
    s_barrier
    ds_read_b128 v[24:27], v7 offset:0
    ds_read_b128 v[28:31], v7 offset:1024
    ds_read_b128 v[32:35], v7 offset:2048
    ds_read_b128 v[36:39], v7 offset:3072
    ds_read_b128 v[40:43], v8 offset:4096
    ds_read_b128 v[44:47], v8 offset:5120
    ds_read_b128 v[48:51], v8 offset:6144
    ds_read_b128 v[52:55], v8 offset:7168
    ds_read_b128 v[56:59], v9 offset:8192
    ds_read_b128 v[60:63], v9 offset:9216
    ds_read_b128 v[64:67], v9 offset:10240
    ds_read_b128 v[68:71], v9 offset:11264
    v_lshlrev_b32 v120, 16, v112
    v_and_b32 v121, s96, v112
    v_lshlrev_b32 v122, 16, v113
    v_and_b32 v123, s96, v113
    v_lshlrev_b32 v124, 16, v114
    v_and_b32 v125, s96, v114
    v_lshlrev_b32 v126, 16, v115
    v_and_b32 v127, s96, v115
    v_lshlrev_b32 v128, 16, v116
    v_and_b32 v129, s96, v116
    v_lshlrev_b32 v130, 16, v117
    v_and_b32 v131, s96, v117
    v_lshlrev_b32 v132, 16, v118
    v_and_b32 v133, s96, v118
    v_lshlrev_b32 v134, 16, v119
    v_and_b32 v135, s96, v119
    v_pk_mul_f32 v[120:121], v[120:121], v[22:23] op_sel_hi:[1,0]
    v_pk_mul_f32 v[122:123], v[122:123], v[22:23] op_sel_hi:[1,0]
    v_pk_mul_f32 v[124:125], v[124:125], v[22:23] op_sel_hi:[1,0]
    v_pk_mul_f32 v[126:127], v[126:127], v[22:23] op_sel_hi:[1,0]
    v_pk_mul_f32 v[128:129], v[128:129], v[22:23] op_sel_hi:[1,0]
    v_pk_mul_f32 v[130:131], v[130:131], v[22:23] op_sel_hi:[1,0]
    v_pk_mul_f32 v[132:133], v[132:133], v[22:23] op_sel_hi:[1,0]
    v_pk_mul_f32 v[134:135], v[134:135], v[22:23] op_sel_hi:[1,0]
    s_waitcnt lgkmcnt(8)
    s_nop 0
    v_pk_add_f32 v[72:73], v[72:73], v[24:25]
    v_pk_add_f32 v[74:75], v[74:75], v[26:27]
    v_pk_add_f32 v[76:77], v[76:77], v[28:29]
    v_pk_add_f32 v[78:79], v[78:79], v[30:31]
    v_pk_add_f32 v[80:81], v[80:81], v[32:33]
    v_pk_add_f32 v[82:83], v[82:83], v[34:35]
    v_pk_add_f32 v[84:85], v[84:85], v[36:37]
    v_pk_add_f32 v[86:87], v[86:87], v[38:39]
    s_waitcnt lgkmcnt(4)
    s_nop 0
    v_pk_add_f32 v[72:73], v[72:73], v[40:41]
    v_pk_add_f32 v[74:75], v[74:75], v[42:43]
    v_pk_add_f32 v[76:77], v[76:77], v[44:45]
    v_pk_add_f32 v[78:79], v[78:79], v[46:47]
    v_pk_add_f32 v[80:81], v[80:81], v[48:49]
    v_pk_add_f32 v[82:83], v[82:83], v[50:51]
    v_pk_add_f32 v[84:85], v[84:85], v[52:53]
    v_pk_add_f32 v[86:87], v[86:87], v[54:55]
    s_waitcnt lgkmcnt(0)
    s_nop 0
    v_pk_add_f32 v[72:73], v[72:73], v[56:57]
    v_pk_add_f32 v[74:75], v[74:75], v[58:59]
    v_pk_add_f32 v[76:77], v[76:77], v[60:61]
    v_pk_add_f32 v[78:79], v[78:79], v[62:63]
    v_pk_add_f32 v[80:81], v[80:81], v[64:65]
    v_pk_add_f32 v[82:83], v[82:83], v[66:67]
    v_pk_add_f32 v[84:85], v[84:85], v[68:69]
    v_pk_add_f32 v[86:87], v[86:87], v[70:71]
    s_waitcnt vmcnt(0)
    v_lshlrev_b32 v88, 16, v136
    v_and_b32 v89, s96, v136
    v_lshlrev_b32 v90, 16, v137
    v_and_b32 v91, s96, v137
    v_lshlrev_b32 v92, 16, v138
    v_and_b32 v93, s96, v138
    v_lshlrev_b32 v94, 16, v139
    v_and_b32 v95, s96, v139
    v_lshlrev_b32 v96, 16, v140
    v_and_b32 v97, s96, v140
    v_lshlrev_b32 v98, 16, v141
    v_and_b32 v99, s96, v141
    v_lshlrev_b32 v100, 16, v142
    v_and_b32 v101, s96, v142
    v_lshlrev_b32 v102, 16, v143
    v_and_b32_e64 v103, s96, v143
    v_pk_mul_f32 v[120:121], v[120:121], v[88:89]
    v_pk_mul_f32 v[122:123], v[122:123], v[90:91]
    v_pk_mul_f32 v[124:125], v[124:125], v[92:93]
    v_pk_mul_f32 v[126:127], v[126:127], v[94:95]
    v_pk_mul_f32 v[128:129], v[128:129], v[96:97]
    v_pk_mul_f32 v[130:131], v[130:131], v[98:99]
    v_pk_mul_f32 v[132:133], v[132:133], v[100:101]
    v_pk_mul_f32 v[134:135], v[134:135], v[102:103]
    v_pk_fma_f32 v[120:121], v[72:73], v[22:23], v[120:121] op_sel:[0,1,0]
    v_pk_fma_f32 v[122:123], v[74:75], v[22:23], v[122:123] op_sel:[0,1,0]
    v_pk_fma_f32 v[124:125], v[76:77], v[22:23], v[124:125] op_sel:[0,1,0]
    v_pk_fma_f32 v[126:127], v[78:79], v[22:23], v[126:127] op_sel:[0,1,0]
    v_pk_fma_f32 v[128:129], v[80:81], v[22:23], v[128:129] op_sel:[0,1,0]
    v_pk_fma_f32 v[130:131], v[82:83], v[22:23], v[130:131] op_sel:[0,1,0]
    v_pk_fma_f32 v[132:133], v[84:85], v[22:23], v[132:133] op_sel:[0,1,0]
    v_pk_fma_f32 v[134:135], v[86:87], v[22:23], v[134:135] op_sel:[0,1,0]
    v_cvt_pk_bf16_f32 v88, v120, v121
    v_cvt_pk_bf16_f32 v89, v122, v123
    v_cvt_pk_bf16_f32 v90, v124, v125
    v_cvt_pk_bf16_f32 v91, v126, v127
    v_cvt_pk_bf16_f32 v92, v128, v129
    v_cvt_pk_bf16_f32 v93, v130, v131
    v_cvt_pk_bf16_f32 v94, v132, v133
    v_cvt_pk_bf16_f32 v95, v134, v135
    ds_write_b64 v18, v[88:89]
    ds_write_b64 v15, v[90:91]
    ds_write_b64 v16, v[92:93]
    ds_write_b64 v17, v[94:95]
    ds_read_b128 v[24:27], v19 offset:0
    ds_read_b128 v[28:31], v19 offset:1024
    s_waitcnt lgkmcnt(1)
    buffer_store_dwordx4 v[24:27], v20, s[32:35], s90 offen sc1
    s_waitcnt lgkmcnt(0)
    buffer_store_dwordx4 v[28:31], v20, s[32:35], s59 offen offset:1024 sc1
    s_endpgm
L_gate:
    s_nop 0
    ds_read_b128 a[64:67], v6 offset:0
    ds_read_b64_tr_b16 a[68:69], v10 offset:0
    ds_read_b64_tr_b16 a[70:71], v10 offset:768
    ds_read_b64_tr_b16 a[72:73], v10 offset:64
    ds_read_b64_tr_b16 a[74:75], v10 offset:832
    ds_read_b128 a[52:55], v142 offset:0
    ds_read_b128 a[80:83], v7 offset:0
    ds_read_b64_tr_b16 a[84:85], v10 offset:3072
    ds_read_b64_tr_b16 a[86:87], v10 offset:3840
    ds_read_b64_tr_b16 a[88:89], v10 offset:3136
    ds_read_b64_tr_b16 a[90:91], v10 offset:3904
    ds_read_b128 a[56:59], v142 offset:32
    s_waitcnt lgkmcnt(6)
    v_mfma_f32_32x32x16_bf16 v[24:39], a[68:71], a[64:67], v[24:39]
    ds_read_b128 a[96:99], v8 offset:0
    ds_read_b64_tr_b16 a[100:101], v10 offset:6144
    ds_read_b64_tr_b16 a[102:103], v10 offset:6912
    v_mfma_f32_32x32x16_bf16 v[40:55], a[72:75], a[64:67], v[40:55]
    ds_read_b64_tr_b16 a[104:105], v10 offset:6208
    ds_read_b64_tr_b16 a[106:107], v10 offset:6976
    v_mfma_f32_16x16x32_bf16 v[56:59], a[52:55], a[64:67], 0
    ds_read_b128 a[60:63], v142 offset:64
    s_waitcnt lgkmcnt(6)
    v_mfma_f32_32x32x16_bf16 v[24:39], a[84:87], a[80:83], v[24:39]
    ds_read_b128 a[64:67], v9 offset:0
    ds_read_b64_tr_b16 a[68:69], v10 offset:9216
    ds_read_b64_tr_b16 a[70:71], v10 offset:9984
    v_mfma_f32_32x32x16_bf16 v[40:55], a[88:91], a[80:83], v[40:55]
    ds_read_b64_tr_b16 a[72:73], v10 offset:9280
    ds_read_b64_tr_b16 a[74:75], v10 offset:10048
    v_mfma_f32_16x16x32_bf16 v[56:59], a[56:59], a[80:83], v[56:59]
    ds_read_b128 a[52:55], v142 offset:96
    s_waitcnt lgkmcnt(0)
    s_barrier
    v_mfma_f32_32x32x16_bf16 v[24:39], a[100:103], a[96:99], v[24:39]
    ds_read_b128 a[80:83], v6 offset:4096
    ds_read_b64_tr_b16 a[84:85], v10 offset:12288
    ds_read_b64_tr_b16 a[86:87], v10 offset:13056
    v_mfma_f32_32x32x16_bf16 v[40:55], a[104:107], a[96:99], v[40:55]
    ds_read_b64_tr_b16 a[88:89], v10 offset:12352
    ds_read_b64_tr_b16 a[90:91], v10 offset:13120
    v_mfma_f32_16x16x32_bf16 v[56:59], a[60:63], a[96:99], v[56:59]
    ds_read_b128 a[56:59], v142 offset:128
    v_mfma_f32_32x32x16_bf16 v[24:39], a[68:71], a[64:67], v[24:39]
    ds_read_b128 a[96:99], v7 offset:4096
    ds_read_b64_tr_b16 a[100:101], v10 offset:15360
    ds_read_b64_tr_b16 a[102:103], v10 offset:16128
    v_mfma_f32_32x32x16_bf16 v[40:55], a[72:75], a[64:67], v[40:55]
    ds_read_b64_tr_b16 a[104:105], v10 offset:15424
    ds_read_b64_tr_b16 a[106:107], v10 offset:16192
    v_mfma_f32_16x16x32_bf16 v[56:59], a[52:55], a[64:67], v[56:59]
    ds_read_b128 a[60:63], v142 offset:160
    s_waitcnt lgkmcnt(6)
    v_mfma_f32_32x32x16_bf16 v[24:39], a[84:87], a[80:83], v[24:39]
    ds_read_b128 a[64:67], v8 offset:4096
    ds_read_b64_tr_b16 a[68:69], v10 offset:18432
    ds_read_b64_tr_b16 a[70:71], v10 offset:19200
    v_lshrrev_b32 v110, 9, v1
    v_mfma_f32_32x32x16_bf16 v[40:55], a[88:91], a[80:83], v[40:55]
    ds_read_b64_tr_b16 a[72:73], v10 offset:18496
    ds_read_b64_tr_b16 a[74:75], v10 offset:19264
    s_lshl_b32 s56, s40, 11
    v_mfma_f32_16x16x32_bf16 v[56:59], a[56:59], a[80:83], v[56:59]
    ds_read_b128 a[52:55], v142 offset:192
    s_add_u32 s58, s56, 102400
    s_waitcnt lgkmcnt(6)
    v_mfma_f32_32x32x16_bf16 v[24:39], a[100:103], a[96:99], v[24:39]
    ds_read_b128 a[80:83], v9 offset:4096
    ds_read_b64_tr_b16 a[84:85], v10 offset:21504
    ds_read_b64_tr_b16 a[86:87], v10 offset:22272
    v_lshl_add_u32 v18, v2, 4, s58
    v_mfma_f32_32x32x16_bf16 v[40:55], a[104:107], a[96:99], v[40:55]
    ds_read_b64_tr_b16 a[88:89], v10 offset:21568
    ds_read_b64_tr_b16 a[90:91], v10 offset:22336
    v_lshl_add_u32 v18, v110, 3, v18
    v_mfma_f32_16x16x32_bf16 v[56:59], a[60:63], a[96:99], v[56:59]
    ds_read_b128 a[56:59], v142 offset:224
    v_add_u32 v19, s58, v1
    s_waitcnt lgkmcnt(0)
    s_barrier
    v_mfma_f32_32x32x16_bf16 v[24:39], a[68:71], a[64:67], v[24:39]
    ds_read_b128 a[96:99], v6 offset:8192
    ds_read_b64_tr_b16 a[100:101], v10 offset:24576
    ds_read_b64_tr_b16 a[102:103], v10 offset:25344
    v_and_b32 v111, 24, v2
    v_mfma_f32_32x32x16_bf16 v[40:55], a[72:75], a[64:67], v[40:55]
    ds_read_b64_tr_b16 a[104:105], v10 offset:24640
    ds_read_b64_tr_b16 a[106:107], v10 offset:25408
    v_lshl_add_u32 v18, v111, 1, v18
    v_mfma_f32_16x16x32_bf16 v[56:59], a[52:55], a[64:67], v[56:59]
    ds_read_b128 a[60:63], v142 offset:256
    v_lshrrev_b32 v20, 6, v1
    v_mfma_f32_32x32x16_bf16 v[24:39], a[84:87], a[80:83], v[24:39]
    ds_read_b128 a[64:67], v7 offset:8192
    ds_read_b64_tr_b16 a[68:69], v10 offset:27648
    ds_read_b64_tr_b16 a[70:71], v10 offset:28416
    v_lshrrev_b32 v111, 3, v1
    v_mfma_f32_32x32x16_bf16 v[40:55], a[88:91], a[80:83], v[40:55]
    ds_read_b64_tr_b16 a[72:73], v10 offset:27712
    ds_read_b64_tr_b16 a[74:75], v10 offset:28480
    v_xor_b32 v111, v111, v1
    v_mfma_f32_16x16x32_bf16 v[56:59], a[56:59], a[80:83], v[56:59]
    ds_read_b128 a[52:55], v142 offset:288
    v_and_b32 v111, 48, v111
    s_waitcnt lgkmcnt(6)
    s_nop 0
    v_mfma_f32_32x32x16_bf16 v[24:39], a[100:103], a[96:99], v[24:39]
    ds_read_b128 a[80:83], v8 offset:8192
    ds_read_b64_tr_b16 a[84:85], v10 offset:30720
    ds_read_b64_tr_b16 a[86:87], v10 offset:31488
    v_lshl_add_u32 v20, v20, 10, v111
    v_mfma_f32_32x32x16_bf16 v[40:55], a[104:107], a[96:99], v[40:55]
    ds_read_b64_tr_b16 a[88:89], v10 offset:30784
    ds_read_b64_tr_b16 a[90:91], v10 offset:31552
    v_lshl_add_u32 v21, v110, 14, v2
    s_waitcnt vmcnt(0)
    s_mov_b64 exec, 1
    buffer_store_dword v4, v3, s[28:31], s54 offen sc1
    s_mov_b64 exec, -1
    v_mfma_f32_16x16x32_bf16 v[56:59], a[60:63], a[96:99], v[56:59]
    ds_read_b128 a[56:59], v142 offset:320
    v_lshlrev_b32 v11, 1, v2
    s_waitcnt lgkmcnt(6)
    v_mfma_f32_32x32x16_bf16 v[24:39], a[68:71], a[64:67], v[24:39]
    ds_read_b128 a[96:99], v9 offset:8192
    ds_read_b64_tr_b16 a[100:101], v10 offset:33792
    ds_read_b64_tr_b16 a[102:103], v10 offset:34560
    v_and_b32 v12, 0x70, v1
    v_mfma_f32_32x32x16_bf16 v[40:55], a[72:75], a[64:67], v[40:55]
    ds_read_b64_tr_b16 a[104:105], v10 offset:33856
    ds_read_b64_tr_b16 a[106:107], v10 offset:34624
    s_lshl_b32 s56, s40, 7
    v_mfma_f32_16x16x32_bf16 v[56:59], a[52:55], a[64:67], v[56:59]
    ds_read_b128 a[60:63], v142 offset:352
    v_add_u32 v12, s56, v12
    s_waitcnt lgkmcnt(0)
    s_barrier
    v_mfma_f32_32x32x16_bf16 v[24:39], a[84:87], a[80:83], v[24:39]
    ds_read_b128 a[64:67], v6 offset:12288
    ds_read_b64_tr_b16 a[68:69], v10 offset:36864
    ds_read_b64_tr_b16 a[70:71], v10 offset:37632
    v_or_b32 v111, 0x1e0, v12
    v_mfma_f32_32x32x16_bf16 v[40:55], a[88:91], a[80:83], v[40:55]
    ds_read_b64_tr_b16 a[72:73], v10 offset:36928
    ds_read_b64_tr_b16 a[74:75], v10 offset:37696
    v_cmp_gt_u32 vcc, 512, v1
    v_mfma_f32_16x16x32_bf16 v[56:59], a[56:59], a[80:83], v[56:59]
    ds_read_b128 a[52:55], v142 offset:384
    v_cndmask_b32 v12, v111, v12, vcc
    v_mfma_f32_32x32x16_bf16 v[24:39], a[100:103], a[96:99], v[24:39]
    ds_read_b128 a[80:83], v7 offset:12288
    ds_read_b64_tr_b16 a[84:85], v10 offset:39936
    ds_read_b64_tr_b16 a[86:87], v10 offset:40704
    v_lshlrev_b32 v12, 0, v12
    v_mfma_f32_32x32x16_bf16 v[40:55], a[104:107], a[96:99], v[40:55]
    ds_read_b64_tr_b16 a[88:89], v10 offset:40000
    ds_read_b64_tr_b16 a[90:91], v10 offset:40768
    s_add_u32 s12, s91, 0
    v_mfma_f32_16x16x32_bf16 v[56:59], a[60:63], a[96:99], v[56:59]
    ds_read_b128 a[56:59], v142 offset:416
    s_add_u32 s13, s91, 8192
    s_waitcnt lgkmcnt(6)
    v_mfma_f32_32x32x16_bf16 v[24:39], a[68:71], a[64:67], v[24:39]
    ds_read_b128 a[96:99], v8 offset:12288
    ds_read_b64_tr_b16 a[100:101], v10 offset:43008
    ds_read_b64_tr_b16 a[102:103], v10 offset:43776
    s_add_u32 s14, s91, 32768
    v_mfma_f32_32x32x16_bf16 v[40:55], a[72:75], a[64:67], v[40:55]
    ds_read_b64_tr_b16 a[104:105], v10 offset:43072
    ds_read_b64_tr_b16 a[106:107], v10 offset:43840
    s_add_u32 s15, s91, 40960
    v_mfma_f32_16x16x32_bf16 v[56:59], a[52:55], a[64:67], v[56:59]
    ds_read_b128 a[60:63], v142 offset:448
    s_add_u32 s16, s91, 65536
    s_waitcnt lgkmcnt(6)
    v_mfma_f32_32x32x16_bf16 v[24:39], a[84:87], a[80:83], v[24:39]
    ds_read_b128 a[64:67], v9 offset:12288
    ds_read_b64_tr_b16 a[68:69], v10 offset:46080
    ds_read_b64_tr_b16 a[70:71], v10 offset:46848
    s_add_u32 s17, s91, 73728
    v_mfma_f32_32x32x16_bf16 v[40:55], a[88:91], a[80:83], v[40:55]
    ds_read_b64_tr_b16 a[72:73], v10 offset:46144
    ds_read_b64_tr_b16 a[74:75], v10 offset:46912
    s_add_u32 s18, s91, 98304
    v_mfma_f32_16x16x32_bf16 v[56:59], a[56:59], a[80:83], v[56:59]
    ds_read_b128 a[52:55], v142 offset:480
    s_add_u32 s19, s91, 106496
    s_waitcnt lgkmcnt(0)
    s_barrier
    v_mfma_f32_32x32x16_bf16 v[24:39], a[100:103], a[96:99], v[24:39]
    ds_read_b128 a[80:83], v6 offset:0
    ds_read_b64_tr_b16 a[84:85], v10 offset:0
    ds_read_b64_tr_b16 a[86:87], v10 offset:768
    s_add_u32 s59, s90, 15360
    v_mfma_f32_32x32x16_bf16 v[40:55], a[104:107], a[96:99], v[40:55]
    ds_read_b64_tr_b16 a[88:89], v10 offset:64
    ds_read_b64_tr_b16 a[90:91], v10 offset:832
    v_mfma_f32_16x16x32_bf16 v[56:59], a[60:63], a[96:99], v[56:59]
    ds_read_b128 a[56:59], v142 offset:512
    v_mfma_f32_32x32x16_bf16 v[24:39], a[68:71], a[64:67], v[24:39]
    ds_read_b128 a[96:99], v7 offset:0
    ds_read_b64_tr_b16 a[100:101], v10 offset:3072
    ds_read_b64_tr_b16 a[102:103], v10 offset:3840
    v_mfma_f32_32x32x16_bf16 v[40:55], a[72:75], a[64:67], v[40:55]
    ds_read_b64_tr_b16 a[104:105], v10 offset:3136
    ds_read_b64_tr_b16 a[106:107], v10 offset:3904
    v_mfma_f32_16x16x32_bf16 v[56:59], a[52:55], a[64:67], v[56:59]
    ds_read_b128 a[60:63], v142 offset:544
    s_waitcnt lgkmcnt(6)
    v_mfma_f32_32x32x16_bf16 v[24:39], a[84:87], a[80:83], v[24:39]
    ds_read_b128 a[64:67], v8 offset:0
    ds_read_b64_tr_b16 a[68:69], v10 offset:6144
    ds_read_b64_tr_b16 a[70:71], v10 offset:6912
    v_mfma_f32_32x32x16_bf16 v[40:55], a[88:91], a[80:83], v[40:55]
    ds_read_b64_tr_b16 a[72:73], v10 offset:6208
    ds_read_b64_tr_b16 a[74:75], v10 offset:6976
    v_mfma_f32_16x16x32_bf16 v[56:59], a[56:59], a[80:83], v[56:59]
    ds_read_b128 a[52:55], v142 offset:576
    s_waitcnt lgkmcnt(6)
    v_mfma_f32_32x32x16_bf16 v[24:39], a[100:103], a[96:99], v[24:39]
    ds_read_b128 a[80:83], v9 offset:0
    ds_read_b64_tr_b16 a[84:85], v10 offset:9216
    ds_read_b64_tr_b16 a[86:87], v10 offset:9984
    v_mfma_f32_32x32x16_bf16 v[40:55], a[104:107], a[96:99], v[40:55]
    ds_read_b64_tr_b16 a[88:89], v10 offset:9280
    ds_read_b64_tr_b16 a[90:91], v10 offset:10048
    v_mfma_f32_16x16x32_bf16 v[56:59], a[60:63], a[96:99], v[56:59]
    ds_read_b128 a[56:59], v142 offset:608
    s_waitcnt lgkmcnt(0)
    s_barrier
    v_mfma_f32_32x32x16_bf16 v[24:39], a[68:71], a[64:67], v[24:39]
    ds_read_b128 a[96:99], v6 offset:4096
    ds_read_b64_tr_b16 a[100:101], v10 offset:12288
    ds_read_b64_tr_b16 a[102:103], v10 offset:13056
    v_mfma_f32_32x32x16_bf16 v[40:55], a[72:75], a[64:67], v[40:55]
    ds_read_b64_tr_b16 a[104:105], v10 offset:12352
    ds_read_b64_tr_b16 a[106:107], v10 offset:13120
    v_mfma_f32_16x16x32_bf16 v[56:59], a[52:55], a[64:67], v[56:59]
    ds_read_b128 a[60:63], v142 offset:640
    v_mfma_f32_32x32x16_bf16 v[24:39], a[84:87], a[80:83], v[24:39]
    ds_read_b128 a[64:67], v7 offset:4096
    ds_read_b64_tr_b16 a[68:69], v10 offset:15360
    ds_read_b64_tr_b16 a[70:71], v10 offset:16128
    v_mfma_f32_32x32x16_bf16 v[40:55], a[88:91], a[80:83], v[40:55]
    ds_read_b64_tr_b16 a[72:73], v10 offset:15424
    ds_read_b64_tr_b16 a[74:75], v10 offset:16192
    v_mfma_f32_16x16x32_bf16 v[56:59], a[56:59], a[80:83], v[56:59]
    ds_read_b128 a[52:55], v142 offset:672
    s_waitcnt lgkmcnt(6)
    v_mfma_f32_32x32x16_bf16 v[24:39], a[100:103], a[96:99], v[24:39]
    ds_read_b128 a[80:83], v8 offset:4096
    ds_read_b64_tr_b16 a[84:85], v10 offset:18432
    ds_read_b64_tr_b16 a[86:87], v10 offset:19200
    v_mfma_f32_32x32x16_bf16 v[40:55], a[104:107], a[96:99], v[40:55]
    ds_read_b64_tr_b16 a[88:89], v10 offset:18496
    ds_read_b64_tr_b16 a[90:91], v10 offset:19264
    v_mfma_f32_16x16x32_bf16 v[56:59], a[60:63], a[96:99], v[56:59]
    ds_read_b128 a[56:59], v142 offset:704
    s_waitcnt lgkmcnt(6)
    v_mfma_f32_32x32x16_bf16 v[24:39], a[68:71], a[64:67], v[24:39]
    ds_read_b128 a[96:99], v9 offset:4096
    ds_read_b64_tr_b16 a[100:101], v10 offset:21504
    ds_read_b64_tr_b16 a[102:103], v10 offset:22272
    v_mfma_f32_32x32x16_bf16 v[40:55], a[72:75], a[64:67], v[40:55]
    ds_read_b64_tr_b16 a[104:105], v10 offset:21568
    ds_read_b64_tr_b16 a[106:107], v10 offset:22336
    v_mfma_f32_16x16x32_bf16 v[56:59], a[52:55], a[64:67], v[56:59]
    ds_read_b128 a[60:63], v142 offset:736
    s_waitcnt lgkmcnt(0)
    s_barrier
    v_mfma_f32_32x32x16_bf16 v[24:39], a[84:87], a[80:83], v[24:39]
    ds_read_b128 a[64:67], v6 offset:8192
    ds_read_b64_tr_b16 a[68:69], v10 offset:24576
    ds_read_b64_tr_b16 a[70:71], v10 offset:25344
    v_mfma_f32_32x32x16_bf16 v[40:55], a[88:91], a[80:83], v[40:55]
    ds_read_b64_tr_b16 a[72:73], v10 offset:24640
    ds_read_b64_tr_b16 a[74:75], v10 offset:25408
    v_mfma_f32_16x16x32_bf16 v[56:59], a[56:59], a[80:83], v[56:59]
    ds_read_b128 a[52:55], v142 offset:768
    v_mfma_f32_32x32x16_bf16 v[24:39], a[100:103], a[96:99], v[24:39]
    ds_read_b128 a[80:83], v7 offset:8192
    ds_read_b64_tr_b16 a[84:85], v10 offset:27648
    ds_read_b64_tr_b16 a[86:87], v10 offset:28416
    v_mfma_f32_32x32x16_bf16 v[40:55], a[104:107], a[96:99], v[40:55]
    ds_read_b64_tr_b16 a[88:89], v10 offset:27712
    ds_read_b64_tr_b16 a[90:91], v10 offset:28480
    v_mfma_f32_16x16x32_bf16 v[56:59], a[60:63], a[96:99], v[56:59]
    ds_read_b128 a[56:59], v142 offset:800
    s_waitcnt lgkmcnt(6)
    v_mfma_f32_32x32x16_bf16 v[24:39], a[68:71], a[64:67], v[24:39]
    ds_read_b128 a[96:99], v8 offset:8192
    ds_read_b64_tr_b16 a[100:101], v10 offset:30720
    ds_read_b64_tr_b16 a[102:103], v10 offset:31488
    v_mfma_f32_32x32x16_bf16 v[40:55], a[72:75], a[64:67], v[40:55]
    ds_read_b64_tr_b16 a[104:105], v10 offset:30784
    ds_read_b64_tr_b16 a[106:107], v10 offset:31552
    v_mfma_f32_16x16x32_bf16 v[56:59], a[52:55], a[64:67], v[56:59]
    ds_read_b128 a[60:63], v142 offset:832
    s_waitcnt lgkmcnt(6)
    v_mfma_f32_32x32x16_bf16 v[24:39], a[84:87], a[80:83], v[24:39]
    ds_read_b128 a[64:67], v9 offset:8192
    ds_read_b64_tr_b16 a[68:69], v10 offset:33792
    ds_read_b64_tr_b16 a[70:71], v10 offset:34560
    v_mfma_f32_32x32x16_bf16 v[40:55], a[88:91], a[80:83], v[40:55]
    ds_read_b64_tr_b16 a[72:73], v10 offset:33856
    ds_read_b64_tr_b16 a[74:75], v10 offset:34624
    v_mfma_f32_16x16x32_bf16 v[56:59], a[56:59], a[80:83], v[56:59]
    ds_read_b128 a[52:55], v142 offset:864
    s_waitcnt lgkmcnt(0)
    s_barrier
    v_mfma_f32_32x32x16_bf16 v[24:39], a[100:103], a[96:99], v[24:39]
    ds_read_b128 a[80:83], v6 offset:12288
    ds_read_b64_tr_b16 a[84:85], v10 offset:36864
    ds_read_b64_tr_b16 a[86:87], v10 offset:37632
    v_mfma_f32_32x32x16_bf16 v[40:55], a[104:107], a[96:99], v[40:55]
    ds_read_b64_tr_b16 a[88:89], v10 offset:36928
    ds_read_b64_tr_b16 a[90:91], v10 offset:37696
    v_mfma_f32_16x16x32_bf16 v[56:59], a[60:63], a[96:99], v[56:59]
    ds_read_b128 a[56:59], v142 offset:896
    v_mfma_f32_32x32x16_bf16 v[24:39], a[68:71], a[64:67], v[24:39]
    ds_read_b128 a[96:99], v7 offset:12288
    ds_read_b64_tr_b16 a[100:101], v10 offset:39936
    ds_read_b64_tr_b16 a[102:103], v10 offset:40704
    v_mfma_f32_32x32x16_bf16 v[40:55], a[72:75], a[64:67], v[40:55]
    ds_read_b64_tr_b16 a[104:105], v10 offset:40000
    ds_read_b64_tr_b16 a[106:107], v10 offset:40768
    v_mfma_f32_16x16x32_bf16 v[56:59], a[52:55], a[64:67], v[56:59]
    ds_read_b128 a[60:63], v142 offset:928
    s_waitcnt lgkmcnt(6)
    v_mfma_f32_32x32x16_bf16 v[24:39], a[84:87], a[80:83], v[24:39]
    ds_read_b128 a[64:67], v8 offset:12288
    ds_read_b64_tr_b16 a[68:69], v10 offset:43008
    ds_read_b64_tr_b16 a[70:71], v10 offset:43776
    v_mfma_f32_32x32x16_bf16 v[40:55], a[88:91], a[80:83], v[40:55]
    ds_read_b64_tr_b16 a[72:73], v10 offset:43072
    ds_read_b64_tr_b16 a[74:75], v10 offset:43840
    v_mfma_f32_16x16x32_bf16 v[56:59], a[56:59], a[80:83], v[56:59]
    ds_read_b128 a[52:55], v142 offset:960
    s_waitcnt lgkmcnt(6)
    v_mfma_f32_32x32x16_bf16 v[24:39], a[100:103], a[96:99], v[24:39]
    ds_read_b128 a[80:83], v9 offset:12288
    ds_read_b64_tr_b16 a[84:85], v10 offset:46080
    ds_read_b64_tr_b16 a[86:87], v10 offset:46848
    v_mfma_f32_32x32x16_bf16 v[40:55], a[104:107], a[96:99], v[40:55]
    ds_read_b64_tr_b16 a[88:89], v10 offset:46144
    ds_read_b64_tr_b16 a[90:91], v10 offset:46912
    v_mfma_f32_16x16x32_bf16 v[56:59], a[60:63], a[96:99], v[56:59]
    ds_read_b128 a[56:59], v142 offset:992
    s_waitcnt lgkmcnt(0)
    s_barrier
    v_mfma_f32_32x32x16_bf16 v[24:39], a[68:71], a[64:67], v[24:39]
    v_mfma_f32_32x32x16_bf16 v[40:55], a[72:75], a[64:67], v[40:55]
    v_mfma_f32_16x16x32_bf16 v[56:59], a[52:55], a[64:67], v[56:59]
    v_mfma_f32_32x32x16_bf16 v[24:39], a[84:87], a[80:83], v[24:39]
    v_mfma_f32_32x32x16_bf16 v[40:55], a[88:91], a[80:83], v[40:55]
    v_mfma_f32_16x16x32_bf16 v[56:59], a[56:59], a[80:83], v[56:59]
    v_and_b32 v140, 256, v1
    v_cmp_ne_u32 vcc, 0, v140
    s_nop 5
    v_cndmask_b32 v140, v56, v57, vcc
    v_cvt_pk_bf16_f32 v140, v140, v140
    v_and_b32 v140, 0xffff0000, v140
    v_mul_f32 v140, 0xbfb8aa3b, v140
    v_exp_f32 v140, v140
    s_nop 0
    v_add_f32 v140, 1.0, v140
    v_rcp_f32 v140, v140
    s_nop 0
    v_cvt_pk_bf16_f32 v140, v140, v140
    v_and_b32 v140, 0xffff0000, v140
    v_sub_f32 v141, 1.0, v140
    v_cvt_pk_bf16_f32 v141, v141, v141
    v_and_b32 v141, 0xffff0000, v141
    s_mov_b32 exec_hi, 0
    buffer_store_dwordx2 v[140:141], v11, s[28:31], s22 offen sc1
    s_mov_b32 exec_hi, -1
    s_waitcnt lgkmcnt(0)
    s_nop 15
    s_nop 3
    s_branch L_join
L_codeend:
.section .rodata,"a"
.p2align 6
.amdhsa_kernel gated_mix__ssm_conv_h3__dense_activation_gelu__prompt_kernel
  .amdhsa_next_free_vgpr 256
  .amdhsa_next_free_sgpr 102
  .amdhsa_accum_offset 144
  .amdhsa_group_segment_fixed_size 0
  .amdhsa_kernarg_size 120
  .amdhsa_user_sgpr_count 2
  .amdhsa_user_sgpr_kernarg_segment_ptr 1
  .amdhsa_system_sgpr_workgroup_id_x 1
  .amdhsa_float_denorm_mode_32 3
.end_amdhsa_kernel
```
